```python
import torch

def _softmax(x, axis=-1):
    return torch.softmax(x, dim=axis)
def _gelu(x):
    return torch.nn.functional.gelu(x, approximate="tanh")
def _silu(x):
    return torch.nn.functional.silu(x)
def _sigmoid(x):
    return torch.sigmoid(x)
def _layernorm(x, axis=-1, eps=1e-5):
    m = x.mean(dim=axis, keepdim=True)
    v = x.var(dim=axis, keepdim=True, unbiased=False)
    return (x - m) / torch.sqrt(v + eps)
def _scatter_add(tgt, idx, src, axis=0):
    return tgt.clone().index_add_(axis, idx, src)
def _segment_sum(src, seg, n):
    out = torch.zeros((n,) + src.shape[1:], dtype=src.dtype)
    return out.index_add_(0, seg, src)
def _pad(x, pw):
    flat = tuple(v for pair in reversed(pw) for v in pair)
    return torch.nn.functional.pad(x, flat)

kernel_name = 'parallel_sum__softmax_full_mha__moe_arch_mod__prompt'

def setup_inputs():

    _w = (lambda a: (lambda t: t.to(torch.bfloat16) if t.is_floating_point() else t)(torch.as_tensor(a)))
    def _A_setup():
        B, S, D = 1, 2048, 640
        return {
            "x": _w((lambda *s: torch.randn(*s, dtype=torch.bfloat16) * 0.05)(B, S, D)),
            "wqkv": _w((lambda *s: torch.randn(*s, dtype=torch.bfloat16) * 0.1)(D, 3 * D)),
            "wo": _w((lambda *s: torch.randn(*s, dtype=torch.bfloat16) * 0.05)(D, D)),
        }
    _A_in = _A_setup()

    def _B_setup():
        B, S, D, F, C = 1, 2048, 640, 1536, 2
        return {
            "x": _w((lambda *s: torch.randn(*s, dtype=torch.bfloat16) * 0.05)(B, S, D)),
            "w_r": _w((lambda *s: torch.randn(*s, dtype=torch.bfloat16) * 3.2)(D)),
            "w_gate": _w((lambda *s: torch.randn(*s, dtype=torch.bfloat16) * 0.1)(D, F)),
            "w_up": _w((lambda *s: torch.randn(*s, dtype=torch.bfloat16) * 0.1)(D, F)),
            "w_down": _w((lambda *s: torch.randn(*s, dtype=torch.bfloat16) * 0.1)(F, D)),
        }
    _B_in = _B_setup()

    return {
        "A_x": _A_in["x"],
        "A_wqkv": _A_in["wqkv"],
        "A_wo": _A_in["wo"],
        "B_x": _B_in["x"],
        "B_w_r": _B_in["w_r"],
        "B_w_gate": _B_in["w_gate"],
        "B_w_up": _B_in["w_up"],
        "B_w_down": _B_in["w_down"],
    }

def reference(A_x, A_wqkv, A_wo, B_x, B_w_r, B_w_gate, B_w_up, B_w_down):
    def _A_ref(x, wqkv, wo):
        B, S, D = x.shape
        H = 32; Dh = D // H
        qkv = (lambda x, *d: x.permute(*d))((x @ wqkv).reshape(B, S, 3, H, Dh), 2, 0, 3, 1, 4)
        q, k, v = qkv[0], qkv[1], qkv[2]
        scale = Dh ** -0.5
        scores = torch.einsum("bhqd,bhkd->bhqk", q, k) * scale
        p = _softmax(scores, axis=-1)
        o = torch.einsum("bhqk,bhkd->bhqd", p, v)
        return (lambda x, *d: x.permute(*d))(o, 0, 2, 1, 3).reshape(B, S, D) @ wo

    def _B_ref(x, w_r, w_gate, w_up, w_down):
        B, S, D = x.shape
        C = 2
        r = x @ w_r
        idx = torch.argsort(-r, axis=-1)[:, :C]
        idx_e = (lambda x, n, axis: torch.repeat_interleave(x, n, dim=axis))(idx.reshape(B, C, 1), D, axis=2)
        x_sel = (lambda x, i, axis: torch.take_along_dim(x, i, dim=axis))(x, idx_e, axis=1)
        g = _silu(x_sel @ w_gate)
        u = x_sel @ w_up
        y = (g * u) @ w_down
        r_sel = _sigmoid((lambda x, i, axis: torch.take_along_dim(x, i, dim=axis))(r, idx, axis=1))
        y = y * r_sel.reshape(B, C, 1)
        b_off = (torch.arange(B) * S).reshape(B, 1)
        flat_idx = (idx + b_off).reshape(B * C)
        zero = (x * 0.0).reshape(B * S, D)
        upd = _scatter_add(zero, flat_idx, y.reshape(B * C, D), axis=0)
        return x + upd.reshape(B, S, D)

    x = A_x
    xn = _layernorm(x, axis=-1)
    return x + _A_ref(xn, A_wqkv, A_wo) + _B_ref(xn, B_w_r, B_w_gate, B_w_up, B_w_down)
```

```asm
; @launch grid=(256,1,1) block=(512,1,1) lds=163840
.amdgcn_target "amdgcn-amd-amdhsa--gfx950"
.text
.globl parallel_sum__softmax_full_mha__moe_arch_mod__prompt_kernel
.p2align 8
.type parallel_sum__softmax_full_mha__moe_arch_mod__prompt_kernel,@function
parallel_sum__softmax_full_mha__moe_arch_mod__prompt_kernel:
    s_cmpk_ge_u32 s2, 0x100
    s_cbranch_scc1 L_end
    s_load_dwordx2 s[4:5], s[0:1], 0
    s_load_dwordx2 s[8:9], s[0:1], 8
    s_load_dwordx2 s[20:21], s[0:1], 32
    v_and_b32 v1, 63, v0
    v_lshrrev_b32 v2, 6, v0
    s_lshr_b32 s45, s2, 3
    s_and_b32 s44, s2, 7
    v_readfirstlane_b32 s24, v2
    s_mul_i32 s54, s45, 9
    s_cmp_lg_u32 s24, 0
    s_cbranch_scc1 L_nowarm0
    s_getpc_b64 s[52:53]
L_pc:
    v_add_u32 v3, s54, v1
    v_cmp_gt_u32 vcc, 9, v1
    v_subrev_u32 v4, 6, v1
    v_min_u32 v4, 20, v4
    v_cndmask_b32 v3, v4, v3, vcc
    v_lshlrev_b32 v3, 7, v3
    v_min_u32 v3, L_end-L_pc, v3
    global_load_dword v255, v3, s[52:53]
L_nowarm0:
    s_and_b32 s46, s45, 3
    s_lshr_b32 s47, s45, 2
    s_and_b32 s28, s44, 3
    s_lshl2_add_u32 s28, s28, s46
    s_lshr_b32 s29, s44, 2
    s_lshl3_add_u32 s29, s29, s47
    s_mul_i32 s56, s46, 3
    s_mul_i32 s48, s47, 5
    s_lshr_b32 s48, s48, 2
    s_add_u32 s56, s56, s48
    s_sub_u32 s48, s56, 10
    s_cmp_ge_u32 s56, 10
    s_cselect_b32 s56, s48, s56
    s_and_b32 s25, s24, 3
    s_lshr_b32 s26, s24, 2
    s_mov_b32 s6, 2621440
    s_mov_b32 s7, 0x00020000
    s_movk_i32 s49, 1280
    v_lshrrev_b32 v3, 3, v1
    s_lshl_b32 s48, s25, 4
    v_add_u32 v4, s48, v3
    v_lshrrev_b32 v5, 1, v4
    v_xor_b32 v5, v5, v1
    v_and_b32 v5, 7, v5
    s_lshl_b32 s50, s28, 7
    v_add_u32 v4, s50, v4
    v_mul_u32_u24 v10, s49, v4
    v_lshl_add_u32 v10, v5, 4, v10
    v_xor_b32 v11, 64, v10
    v_add_u32 v11, 10240, v11
    s_mul_i32 s30, s26, 81920
    s_lshl_b32 s37, s24, 11
    s_lshl_b32 s40, s56, 7
    s_add_u32 s41, s40, s30
    s_mov_b32 m0, s37
    v_and_b32 v15, 31, v1
    v_lshlrev_b32 v16, 4, v15
    v_lshrrev_b32 v13, 5, v1
    v_mul_u32_u24 v13, s49, v13
    v_add_u32 v13, v13, v16
    s_lshl3_add_u32 s55, s29, s50
    s_lshl1_add_u32 s51, s25, s55
    s_mul_i32 s51, s51, s49
    v_cmp_gt_u32 vcc, 16, v15
    s_mov_b32 s22, s49
    s_mov_b32 s23, s7
    v_cndmask_b32 v14, 2.0, v13, vcc
    s_cmp_lg_u32 s26, 0
    s_waitcnt lgkmcnt(0)
    s_cbranch_scc1 L_noep0
    buffer_load_dwordx4 v[40:43], v13, s[4:7], s51 offen
    buffer_load_dwordx4 v[44:47], v13, s[4:7], s51 offen offset:512
    buffer_load_dwordx4 v[48:51], v14, s[4:7], s51 offen offset:1024
    buffer_load_dwordx4 v[64:67], v16, s[20:23], 0 offen
    buffer_load_dwordx4 v[68:71], v16, s[20:23], 0 offen offset:512
    buffer_load_dwordx4 v[72:75], v16, s[20:23], 0 offen offset:1024
L_noep0:
    s_cmp_eq_u32 s29, 15
    s_cbranch_scc1 L_nox0
    buffer_load_dwordx4 v10, s[4:7], s41 offen lds
    s_add_u32 m0, s37, 1024
    s_nop 0
    buffer_load_dwordx4 v11, s[4:7], s41 offen lds
L_nox0:
L_fast_end:
    s_load_dwordx2 s[12:13], s[0:1], 80
    s_load_dwordx2 s[16:17], s[0:1], 64
    s_mov_b32 s57, s56
    s_mov_b32 s59, s56
    s_add_u32 s56, s56, 1
    s_cmp_eq_u32 s56, 10
    s_cselect_b32 s56, 0, s56
    s_mul_i32 s35, s29, 52
    s_lshr_b32 s35, s35, 8
    s_mul_i32 s48, s35, 5
    s_sub_u32 s36, s29, s48
    s_mul_i32 s49, s35, 1280
    s_lshl_b32 s48, s36, 7
    s_add_u32 s49, s49, s48
    s_lshl_b32 s38, s24, 10
    s_add_u32 s38, s38, 65536
    s_mul_i32 s39, s26, 122880
    s_lshl_b32 s48, s25, 3
    v_add_u32 v4, s48, v3
    v_mul_u32_u24 v12, 3840, v4
    v_lshrrev_b32 v5, 2, v1
    v_and_b32 v5, 4, v5
    v_xor_b32 v5, v5, v1
    v_and_b32 v5, 7, v5
    v_lshl_add_u32 v12, v5, 4, v12
    v_add_u32 v12, s49, v12
    v_add_u32 v14, 1024, v13
    v_cmp_gt_u32 vcc, 16, v15
    s_mov_b32 s27, 0
    s_mov_b32 s10, 2457600
    s_mov_b32 s11, 0x00020000
    s_mov_b32 s22, 1280
    s_mov_b32 s23, 0x00020000
    v_cndmask_b32 v14, -1, v14, vcc
    s_cmp_lg_u32 s26, 0
    s_cbranch_scc1 L_noep
    s_waitcnt lgkmcnt(0)
    s_load_dword s27, s[12:13], 0
L_noep:
    s_cmp_eq_u32 s29, 15
    s_cbranch_scc1 L_nodma
    s_mul_i32 s42, s59, 245760
    s_add_u32 m0, s38, 0
    s_add_u32 s43, s42, s39
    s_add_u32 s59, s59, 1
    s_cmp_eq_u32 s59, 10
    s_cselect_b32 s59, 0, s59
    buffer_load_dwordx4 v12, s[8:11], s43 offen lds
    s_barrier
    s_mul_i32 s42, s59, 245760
    s_add_u32 m0, s38, 8192
    s_add_u32 s43, s42, s39
    s_add_u32 s59, s59, 1
    s_cmp_eq_u32 s59, 10
    s_cselect_b32 s59, 0, s59
    buffer_load_dwordx4 v12, s[8:11], s43 offen lds
    s_mul_i32 s42, s59, 245760
    s_add_u32 m0, s38, 16384
    s_add_u32 s43, s42, s39
    s_add_u32 s59, s59, 1
    s_cmp_eq_u32 s59, 10
    s_cselect_b32 s59, 0, s59
    buffer_load_dwordx4 v12, s[8:11], s43 offen lds
L_nodma:
    s_and_b32 s31, s45, 15
    s_lshr_b32 s32, s45, 4
    s_lshl_b32 s48, s44, 1
    s_add_u32 s32, s32, s48
    s_lshl_b32 s33, s44, 2
    s_add_u32 s33, s33, s46
    s_mov_b32 s34, s47
    s_mov_b32 s60, -1
    s_mov_b32 s61, 0
    s_mov_b32 s62, 0xfffff
    s_mov_b32 s63, 0xfffff
    s_mov_b32 s64, 0
    s_mov_b32 s65, 0
    s_mul_i32 s50, s2, 2731
    s_lshr_b32 s50, s50, 16
    s_mul_i32 s51, s50, 24
    s_sub_u32 s51, s2, s51
    s_mov_b32 s14, 268435456
    s_mov_b32 s15, 0x00020000
    s_mov_b32 s18, 2621440
    s_mov_b32 s19, 0x00020000
    s_cmp_lg_u32 s24, 0
    s_cbranch_scc1 L_nowarm
    v_lshlrev_b32 v3, 2, v1
    v_add_u32 v3, 156928, v3
    v_mov_b32 v4, 0
    ds_write_b32 v3, v4
L_nowarm:
    v_and_b32 v32, 31, v1
    v_and_b32 v33, 4, v1
    v_lshlrev_b32 v33, 1, v33
    v_and_b32 v34, 8, v1
    v_lshrrev_b32 v34, 1, v34
    v_and_b32 v35, 19, v1
    v_or3_b32 v33, v33, v34, v35
    s_cmp_eq_u32 s35, 2
    s_cselect_b64 vcc, -1, 0
    v_cndmask_b32 v36, v32, v33, vcc
    s_lshl_b32 s41, s25, 5
    v_add_u32 v36, s41, v36
    s_lshl_b32 s41, s28, 7
    v_add_lshl_u32 v20, s41, v36, 3
    v_lshrrev_b32 v33, 1, v36
    v_lshrrev_b32 v34, 5, v1
    v_xor_b32 v33, v33, v34
    v_and_b32 v33, 7, v33
    v_lshlrev_b32 v33, 4, v33
    v_lshl_add_u32 v33, v36, 7, v33
    s_lshl_b32 s41, s25, 5
    v_xor_b32 v2, s41, v33
    v_xor_b32 v3, 32, v2
    v_xor_b32 v4, 64, v2
    v_xor_b32 v5, 0x60, v2
    v_bfe_u32 v36, v1, 2, 2
    v_lshl_add_u32 v33, v34, 3, v36
    v_lshlrev_b32 v33, 7, v33
    v_bfe_u32 v35, v1, 4, 1
    v_lshlrev_b32 v35, 5, v35
    v_and_b32 v37, 1, v1
    v_lshlrev_b32 v37, 4, v37
    v_or3_b32 v33, v33, v35, v37
    v_bfe_u32 v35, v1, 1, 1
    v_lshlrev_b32 v35, 3, v35
    v_lshrrev_b32 v36, 1, v36
    v_lshlrev_b32 v36, 6, v36
    v_or3_b32 v33, v33, v35, v36
    s_lshl_b32 s41, s25, 11
    s_add_u32 s41, s41, 65536
    v_xor_b32 v6, s41, v33
    v_xor_b32 v7, 0x800, v6
    v_xor_b32 v8, 0x1000, v6
    v_xor_b32 v9, 0x1800, v6
    v_mov_b32 v16, 0
    v_mov_b32 v17, 0
    v_mov_b32 v18, 0x3f803f80
    s_mov_b32 s41, 0x3ea52b5c
    s_cmp_eq_u32 s35, 0
    s_cselect_b32 s58, s41, 1.0
    v_lshl_add_u32 v22, v32, 1, v34
    v_lshlrev_b32 v22, 4, v22
    s_lshl_b32 s40, s26, 11
    s_add_u32 s40, s40, 135168
    v_add_u32 v22, s40, v22
    s_lshl_b32 s40, s25, 2
    v_add_u32 v21, s40, v22
    v_lshlrev_b32 v23, 4, v1
    v_mul_u32_u24 v33, 10240, v34
    v_lshl_add_u32 v33, v32, 4, v33
    s_cmp_eq_u32 s35, 2
    s_cselect_b64 vcc, -1, 0
    v_cndmask_b32 v23, v23, v33, vcc
    s_movk_i32 s53, 1024
    s_movk_i32 s54, 20480
    s_cselect_b32 s53, s54, s53
    s_cselect_b32 s42, 5120, s54
    s_movk_i32 s54, 2048
    s_cselect_b32 s54, 512, s54
    s_mul_i32 s42, s42, s26
    s_lshl_b32 s40, s28, 2
    s_add_u32 s40, s40, s25
    s_mul_i32 s40, s40, 40960
    s_add_u32 s40, s40, s42
    s_mul_i32 s41, s35, 2621440
    s_add_u32 s40, s40, s41
    s_lshl_b32 s41, s36, 1
    s_mul_i32 s41, s41, s54
    s_add_u32 s40, s40, s41
    s_add_u32 s52, s40, 1048576
    v_lshlrev_b32 v33, 3, v34
    v_sub_u32 v32, v32, v33
    v_mov_b32 v35, 0x3f80
    v_mov_b32 v36, 1.0
    v_cmp_eq_u32 vcc, 0, v32
    v_cmp_eq_u32 s[40:41], 1, v32
    s_nop 0
    v_cndmask_b32 v33, 0, v35, vcc
    v_cndmask_b32 v24, v33, v36, s[40:41]
    v_cmp_eq_u32 vcc, 2, v32
    v_cmp_eq_u32 s[40:41], 3, v32
    s_nop 0
    v_cndmask_b32 v33, 0, v35, vcc
    v_cndmask_b32 v25, v33, v36, s[40:41]
    v_cmp_eq_u32 vcc, 4, v32
    v_cmp_eq_u32 s[40:41], 5, v32
    s_nop 0
    v_cndmask_b32 v33, 0, v35, vcc
    v_cndmask_b32 v26, v33, v36, s[40:41]
    v_cmp_eq_u32 vcc, 6, v32
    v_cmp_eq_u32 s[40:41], 7, v32
    s_nop 0
    v_cndmask_b32 v33, 0, v35, vcc
    v_cndmask_b32 v27, v33, v36, s[40:41]
    v_cmp_eq_u32 vcc, 16, v32
    v_cmp_eq_u32 s[40:41], 17, v32
    s_nop 0
    v_cndmask_b32 v33, 0, v35, vcc
    v_cndmask_b32 v28, v33, v36, s[40:41]
    v_cmp_eq_u32 vcc, 18, v32
    v_cmp_eq_u32 s[40:41], 19, v32
    s_nop 0
    v_cndmask_b32 v33, 0, v35, vcc
    v_cndmask_b32 v29, v33, v36, s[40:41]
    v_cmp_eq_u32 vcc, 20, v32
    v_cmp_eq_u32 s[40:41], 21, v32
    s_nop 0
    v_cndmask_b32 v33, 0, v35, vcc
    v_cndmask_b32 v30, v33, v36, s[40:41]
    v_cmp_eq_u32 vcc, 22, v32
    v_cmp_eq_u32 s[40:41], 23, v32
    s_nop 0
    v_cndmask_b32 v33, 0, v35, vcc
    v_cndmask_b32 v31, v33, v36, s[40:41]
    s_cmp_lg_u32 s24, 7
    s_cbranch_scc1 L_notab
    v_lshrrev_b32 v81, 4, v1
    v_and_b32 v80, 15, v1
    v_bfe_u32 v82, v1, 2, 2
    v_and_b32 v83, 3, v1
    v_mul_u32_u24 v83, 40, v83
    v_lshrrev_b32 v84, 1, v81
    v_mul_u32_u24 v84, 20, v84
    v_and_b32 v85, 1, v81
    v_lshl_add_u32 v84, v85, 2, v84
    v_add_u32 v84, v84, v82
    v_mul_u32_u24 v84, 160, v84
    v_add_u32 v88, v84, v83
    v_mul_u32_u24 v84, 40, v81
    v_add3_u32 v85, v84, v82, 16
    v_mul_u32_u24 v85, 160, v85
    v_add_u32 v89, v85, v83
    v_lshlrev_b32 v90, 8, v81
    v_lshl_add_u32 v90, v80, 3, v90
    v_mul_u32_u24 v91, 1280, v80
    v_add_u32 v91, v91, v84
    v_mul_u32_u24 v92, 336, v80
    v_lshl_add_u32 v92, v84, 1, v92
    s_mov_b32 s40, 0x1999999a
    v_mul_hi_u32 v82, v1, s40
    v_mul_u32_u24 v83, 10, v82
    v_sub_u32 v83, v1, v83
    v_mul_u32_u24 v95, 1280, v82
    v_lshl_add_u32 v95, v83, 4, v95
    v_min_u32 v86, 39, v1
    v_mul_hi_u32 v82, v86, s40
    v_mul_u32_u24 v83, 10, v82
    v_sub_u32 v83, v86, v83
    v_mul_u32_u24 v93, 336, v82
    v_lshl_add_u32 v93, v83, 5, v93
    v_mul_u32_u24 v94, 1280, v82
    v_lshl_add_u32 v94, v83, 4, v94
    v_lshlrev_b32 v80, 4, v1
    v_add_u32 v80, 160512, v80
    ds_write_b128 v80, v[88:91]
    ds_write_b128 v80, v[92:95] offset:1024
L_notab:
    s_cmp_eq_u32 s29, 15
    s_cbranch_scc1 L_spare
    s_cmp_lg_u32 s26, 0
    s_cbranch_scc1 L_p1b
    v_xor_b32 v92, 64, v6
    v_xor_b32 v93, 64, v7
    v_xor_b32 v94, 64, v8
    v_xor_b32 v95, 64, v9
    s_setprio 1
    s_waitcnt vmcnt(5)
    v_mov_b32 v56, 0
    v_mov_b32 v57, 0
    v_mov_b32 v58, 0
    v_mov_b32 v59, 0
    v_dot2c_f32_bf16 v56, v40, v40
    v_dot2c_f32_bf16 v57, v40, v18
    v_dot2c_f32_bf16 v58, v40, v64
    v_dot2c_f32_bf16 v59, v64, v18
    v_dot2c_f32_bf16 v56, v41, v41
    v_dot2c_f32_bf16 v57, v41, v18
    v_dot2c_f32_bf16 v58, v41, v65
    v_dot2c_f32_bf16 v59, v65, v18
    v_dot2c_f32_bf16 v56, v42, v42
    v_dot2c_f32_bf16 v57, v42, v18
    v_dot2c_f32_bf16 v58, v42, v66
    v_dot2c_f32_bf16 v59, v66, v18
    v_dot2c_f32_bf16 v56, v43, v43
    v_dot2c_f32_bf16 v57, v43, v18
    v_dot2c_f32_bf16 v58, v43, v67
    v_dot2c_f32_bf16 v59, v67, v18
    v_dot2c_f32_bf16 v56, v44, v44
    v_dot2c_f32_bf16 v57, v44, v18
    v_dot2c_f32_bf16 v58, v44, v68
    v_dot2c_f32_bf16 v59, v68, v18
    v_dot2c_f32_bf16 v56, v45, v45
    v_dot2c_f32_bf16 v57, v45, v18
    v_dot2c_f32_bf16 v58, v45, v69
    v_dot2c_f32_bf16 v59, v69, v18
    v_dot2c_f32_bf16 v56, v46, v46
    v_dot2c_f32_bf16 v57, v46, v18
    v_dot2c_f32_bf16 v58, v46, v70
    v_dot2c_f32_bf16 v59, v70, v18
    v_dot2c_f32_bf16 v56, v47, v47
    v_dot2c_f32_bf16 v57, v47, v18
    v_dot2c_f32_bf16 v58, v47, v71
    v_dot2c_f32_bf16 v59, v71, v18
    v_dot2c_f32_bf16 v56, v48, v48
    v_dot2c_f32_bf16 v57, v48, v18
    v_dot2c_f32_bf16 v58, v48, v72
    v_dot2c_f32_bf16 v59, v72, v18
    v_dot2c_f32_bf16 v56, v49, v49
    v_dot2c_f32_bf16 v57, v49, v18
    v_dot2c_f32_bf16 v58, v49, v73
    v_dot2c_f32_bf16 v59, v73, v18
    v_dot2c_f32_bf16 v56, v50, v50
    v_dot2c_f32_bf16 v57, v50, v18
    v_dot2c_f32_bf16 v58, v50, v74
    v_dot2c_f32_bf16 v59, v74, v18
    v_dot2c_f32_bf16 v56, v51, v51
    v_dot2c_f32_bf16 v57, v51, v18
    v_dot2c_f32_bf16 v58, v51, v75
    v_dot2c_f32_bf16 v59, v75, v18
    s_waitcnt lgkmcnt(0)
    s_nop 2
    v_add_f32_dpp v56, v56, v56 row_ror:1 row_mask:0xf bank_mask:0xf
    v_add_f32_dpp v57, v57, v57 row_ror:1 row_mask:0xf bank_mask:0xf
    v_add_f32_dpp v58, v58, v58 row_ror:1 row_mask:0xf bank_mask:0xf
    v_add_f32_dpp v59, v59, v59 row_ror:1 row_mask:0xf bank_mask:0xf
    v_add_f32_dpp v56, v56, v56 row_ror:2 row_mask:0xf bank_mask:0xf
    v_add_f32_dpp v57, v57, v57 row_ror:2 row_mask:0xf bank_mask:0xf
    v_add_f32_dpp v58, v58, v58 row_ror:2 row_mask:0xf bank_mask:0xf
    v_add_f32_dpp v59, v59, v59 row_ror:2 row_mask:0xf bank_mask:0xf
    v_add_f32_dpp v56, v56, v56 row_ror:4 row_mask:0xf bank_mask:0xf
    v_add_f32_dpp v57, v57, v57 row_ror:4 row_mask:0xf bank_mask:0xf
    v_add_f32_dpp v58, v58, v58 row_ror:4 row_mask:0xf bank_mask:0xf
    v_add_f32_dpp v59, v59, v59 row_ror:4 row_mask:0xf bank_mask:0xf
    v_add_f32_dpp v56, v56, v56 row_ror:8 row_mask:0xf bank_mask:0xf
    v_add_f32_dpp v57, v57, v57 row_ror:8 row_mask:0xf bank_mask:0xf
    v_add_f32_dpp v58, v58, v58 row_ror:8 row_mask:0xf bank_mask:0xf
    v_add_f32_dpp v59, v59, v59 row_ror:8 row_mask:0xf bank_mask:0xf
    v_add_f32_dpp v56, v56, v56 row_bcast:15 row_mask:0xa bank_mask:0xf
    v_add_f32_dpp v57, v57, v57 row_bcast:15 row_mask:0xa bank_mask:0xf
    v_add_f32_dpp v58, v58, v58 row_bcast:15 row_mask:0xa bank_mask:0xf
    v_add_f32_dpp v59, v59, v59 row_bcast:15 row_mask:0xa bank_mask:0xf
    v_mul_f32 v57, 0x3acccccd, v57
    v_mul_f32 v56, 0x3acccccd, v56
    v_fma_f32 v56, -v57, v57, v56
    v_max_f32 v56, 0, v56
    v_cvt_pk_bf16_f32 v57, v57, v57
    v_lshlrev_b32 v57, 16, v57
    v_cvt_pk_bf16_f32 v56, v56, v56
    v_lshlrev_b32 v56, 16, v56
    v_add_f32 v56, 0x3727c5ac, v56
    v_cvt_pk_bf16_f32 v56, v56, v56
    v_lshlrev_b32 v56, 16, v56
    v_sqrt_f32 v56, v56
    v_fma_f32 v58, -v57, v59, v58
    v_cvt_pk_bf16_f32 v56, v56, v56
    v_lshlrev_b32 v56, 16, v56
    v_rcp_f32 v59, v56
    v_lshrrev_b32 v57, 16, v57
    v_or_b32 v60, v57, v56
    v_mul_f32 v58, v58, v59
    v_cvt_pk_bf16_f32 v58, v58, v58
    v_lshlrev_b32 v58, 16, v58
    s_lshl_b32 s40, s25, 1
    s_add_u32 s40, s40, s55
    v_add_u32 v57, s40, v34
    v_ashrrev_i32 v59, 31, v58
    v_or_b32 v59, 0x80000000, v59
    v_xor_b32 v58, v58, v59
    v_and_b32 v58, 0xffff0000, v58
    v_sub_u32 v59, 2047, v57
    v_or_b32 v62, v59, v58
    s_add_u32 s27, s27, 0x9e3779b1
    v_mov_b32 v59, 156960
    v_mov_b32 v61, s27
    v_mov_b32 v63, s27
    v_lshlrev_b32 v57, 3, v57
    s_mov_b32 s40, 65536
    s_mov_b32 s41, 81920
    s_brev_b32 exec_lo, 1
    s_brev_b32 exec_hi, 1
    buffer_store_dwordx2 v[60:61], v57, s[12:15], s40 offen sc1
    buffer_store_dwordx2 v[62:63], v57, s[12:15], s41 offen sc1
    s_mov_b64 exec, -1
    s_cmp_lg_u32 s24, 0
    s_cbranch_scc1 L_epd_1
    ds_write_b32 v59, v61
L_epd_1:
    s_waitcnt vmcnt(4)
    s_waitcnt lgkmcnt(0)
    s_barrier
    ds_read_b128 v[96:99], v2 offset:0
    ds_read_b64_tr_b16 v[128:129], v6 offset:0
    ds_read_b64_tr_b16 v[130:131], v6 offset:512
    ds_read_b64_tr_b16 v[144:145], v92 offset:0
    ds_read_b64_tr_b16 v[146:147], v92 offset:512
    ds_read_b128 v[100:103], v3 offset:0
    ds_read_b64_tr_b16 v[132:133], v7 offset:0
    ds_read_b64_tr_b16 v[134:135], v7 offset:512
    ds_read_b64_tr_b16 v[148:149], v93 offset:0
    ds_read_b64_tr_b16 v[150:151], v93 offset:512
    s_waitcnt lgkmcnt(5)
    ds_read_b128 v[104:107], v4 offset:0
    ds_read_b64_tr_b16 v[136:137], v8 offset:0
    ds_read_b64_tr_b16 v[138:139], v8 offset:512
    ds_read_b64_tr_b16 v[152:153], v94 offset:0
    ds_read_b64_tr_b16 v[154:155], v94 offset:512
    ds_read_b128 v[108:111], v5 offset:0
    ds_read_b64_tr_b16 v[140:141], v9 offset:0
    ds_read_b64_tr_b16 v[142:143], v9 offset:512
    ds_read_b64_tr_b16 v[156:157], v95 offset:0
    ds_read_b64_tr_b16 v[158:159], v95 offset:512
    s_waitcnt vmcnt(0)
    s_waitcnt lgkmcnt(0)
    s_barrier
    v_dot2c_f32_bf16 v16, v128, v18
    v_dot2c_f32_bf16 v17, v144, v18
    v_dot2c_f32_bf16 v16, v129, v18
    v_dot2c_f32_bf16 v17, v145, v18
    v_dot2c_f32_bf16 v16, v130, v18
    v_dot2c_f32_bf16 v17, v146, v18
    v_dot2c_f32_bf16 v16, v131, v18
    v_dot2c_f32_bf16 v17, v147, v18
    v_mfma_f32_32x32x16_bf16 v[32:47], v[128:131], v[96:99], 0
    ds_read_b128 v[112:115], v2 offset:16384
    ds_read_b64_tr_b16 v[160:161], v6 offset:8192
    ds_read_b64_tr_b16 v[162:163], v6 offset:8704
    ds_read_b64_tr_b16 v[176:177], v92 offset:8192
    v_mfma_f32_32x32x16_bf16 v[48:63], v[144:147], v[96:99], 0
    ds_read_b64_tr_b16 v[178:179], v92 offset:8704
    ds_read_b128 v[116:119], v3 offset:16384
    ds_read_b64_tr_b16 v[164:165], v7 offset:8192
    ds_read_b64_tr_b16 v[166:167], v7 offset:8704
    v_mfma_f32_32x32x16_bf16 v[32:47], v[132:135], v[100:103], v[32:47]
    ds_read_b64_tr_b16 v[180:181], v93 offset:8192
    ds_read_b64_tr_b16 v[182:183], v93 offset:8704
    ds_read_b128 v[120:123], v4 offset:16384
    ds_read_b64_tr_b16 v[168:169], v8 offset:8192
    v_mfma_f32_32x32x16_bf16 v[48:63], v[148:151], v[100:103], v[48:63]
    s_waitcnt lgkmcnt(11)
    ds_read_b64_tr_b16 v[170:171], v8 offset:8704
    ds_read_b64_tr_b16 v[184:185], v94 offset:8192
    ds_read_b64_tr_b16 v[186:187], v94 offset:8704
    ds_read_b128 v[124:127], v5 offset:16384
    v_mfma_f32_32x32x16_bf16 v[32:47], v[136:139], v[104:107], v[32:47]
    s_waitcnt lgkmcnt(11)
    ds_read_b64_tr_b16 v[172:173], v9 offset:8192
    ds_read_b64_tr_b16 v[174:175], v9 offset:8704
    ds_read_b64_tr_b16 v[188:189], v95 offset:8192
    ds_read_b64_tr_b16 v[190:191], v95 offset:8704
    v_mfma_f32_32x32x16_bf16 v[48:63], v[152:155], v[104:107], v[48:63]
    v_mfma_f32_32x32x16_bf16 v[32:47], v[140:143], v[108:111], v[32:47]
    v_mfma_f32_32x32x16_bf16 v[48:63], v[156:159], v[108:111], v[48:63]
    s_waitcnt lgkmcnt(0)
    s_barrier
    v_dot2c_f32_bf16 v16, v160, v18
    v_dot2c_f32_bf16 v17, v176, v18
    v_dot2c_f32_bf16 v16, v161, v18
    v_dot2c_f32_bf16 v17, v177, v18
    v_dot2c_f32_bf16 v16, v162, v18
    v_dot2c_f32_bf16 v17, v178, v18
    v_dot2c_f32_bf16 v16, v163, v18
    v_dot2c_f32_bf16 v17, v179, v18
    v_mfma_f32_32x32x16_bf16 v[32:47], v[160:163], v[112:115], v[32:47]
    ds_read_b128 v[96:99], v2 offset:32768
    ds_read_b64_tr_b16 v[128:129], v6 offset:16384
    ds_read_b64_tr_b16 v[130:131], v6 offset:16896
    ds_read_b64_tr_b16 v[144:145], v92 offset:16384
    v_mfma_f32_32x32x16_bf16 v[48:63], v[176:179], v[112:115], v[48:63]
    ds_read_b64_tr_b16 v[146:147], v92 offset:16896
    ds_read_b128 v[100:103], v3 offset:32768
    ds_read_b64_tr_b16 v[132:133], v7 offset:16384
    ds_read_b64_tr_b16 v[134:135], v7 offset:16896
    v_mfma_f32_32x32x16_bf16 v[32:47], v[164:167], v[116:119], v[32:47]
    ds_read_b64_tr_b16 v[148:149], v93 offset:16384
    ds_read_b64_tr_b16 v[150:151], v93 offset:16896
    ds_read_b128 v[104:107], v4 offset:32768
    ds_read_b64_tr_b16 v[136:137], v8 offset:16384
    v_mfma_f32_32x32x16_bf16 v[48:63], v[180:183], v[116:119], v[48:63]
    s_waitcnt lgkmcnt(11)
    ds_read_b64_tr_b16 v[138:139], v8 offset:16896
    ds_read_b64_tr_b16 v[152:153], v94 offset:16384
    ds_read_b64_tr_b16 v[154:155], v94 offset:16896
    ds_read_b128 v[108:111], v5 offset:32768
    v_mfma_f32_32x32x16_bf16 v[32:47], v[168:171], v[120:123], v[32:47]
    s_waitcnt lgkmcnt(11)
    ds_read_b64_tr_b16 v[140:141], v9 offset:16384
    ds_read_b64_tr_b16 v[142:143], v9 offset:16896
    ds_read_b64_tr_b16 v[156:157], v95 offset:16384
    ds_read_b64_tr_b16 v[158:159], v95 offset:16896
    v_mfma_f32_32x32x16_bf16 v[48:63], v[184:187], v[120:123], v[48:63]
    v_mfma_f32_32x32x16_bf16 v[32:47], v[172:175], v[124:127], v[32:47]
    v_mfma_f32_32x32x16_bf16 v[48:63], v[188:191], v[124:127], v[48:63]
    s_waitcnt lgkmcnt(0)
    s_barrier
    v_dot2c_f32_bf16 v16, v128, v18
    v_dot2c_f32_bf16 v17, v144, v18
    v_dot2c_f32_bf16 v16, v129, v18
    v_dot2c_f32_bf16 v17, v145, v18
    v_dot2c_f32_bf16 v16, v130, v18
    v_dot2c_f32_bf16 v17, v146, v18
    v_dot2c_f32_bf16 v16, v131, v18
    v_dot2c_f32_bf16 v17, v147, v18
    v_mfma_f32_32x32x16_bf16 v[32:47], v[128:131], v[96:99], v[32:47]
    ds_read_b128 v[112:115], v2 offset:49152
    ds_read_b64_tr_b16 v[160:161], v6 offset:24576
    ds_read_b64_tr_b16 v[162:163], v6 offset:25088
    ds_read_b64_tr_b16 v[176:177], v92 offset:24576
    v_mfma_f32_32x32x16_bf16 v[48:63], v[144:147], v[96:99], v[48:63]
    ds_read_b64_tr_b16 v[178:179], v92 offset:25088
    ds_read_b128 v[116:119], v3 offset:49152
    ds_read_b64_tr_b16 v[164:165], v7 offset:24576
    ds_read_b64_tr_b16 v[166:167], v7 offset:25088
    v_mfma_f32_32x32x16_bf16 v[32:47], v[132:135], v[100:103], v[32:47]
    ds_read_b64_tr_b16 v[180:181], v93 offset:24576
    ds_read_b64_tr_b16 v[182:183], v93 offset:25088
    ds_read_b128 v[120:123], v4 offset:49152
    ds_read_b64_tr_b16 v[168:169], v8 offset:24576
    v_mfma_f32_32x32x16_bf16 v[48:63], v[148:151], v[100:103], v[48:63]
    s_waitcnt lgkmcnt(11)
    ds_read_b64_tr_b16 v[170:171], v8 offset:25088
    ds_read_b64_tr_b16 v[184:185], v94 offset:24576
    ds_read_b64_tr_b16 v[186:187], v94 offset:25088
    ds_read_b128 v[124:127], v5 offset:49152
    v_mfma_f32_32x32x16_bf16 v[32:47], v[136:139], v[104:107], v[32:47]
    s_waitcnt lgkmcnt(11)
    ds_read_b64_tr_b16 v[172:173], v9 offset:24576
    ds_read_b64_tr_b16 v[174:175], v9 offset:25088
    ds_read_b64_tr_b16 v[188:189], v95 offset:24576
    ds_read_b64_tr_b16 v[190:191], v95 offset:25088
    v_mfma_f32_32x32x16_bf16 v[48:63], v[152:155], v[104:107], v[48:63]
    v_mfma_f32_32x32x16_bf16 v[32:47], v[140:143], v[108:111], v[32:47]
    v_mfma_f32_32x32x16_bf16 v[48:63], v[156:159], v[108:111], v[48:63]
    s_waitcnt lgkmcnt(0)
    s_barrier
    v_dot2c_f32_bf16 v16, v160, v18
    v_dot2c_f32_bf16 v17, v176, v18
    v_dot2c_f32_bf16 v16, v161, v18
    v_dot2c_f32_bf16 v17, v177, v18
    v_dot2c_f32_bf16 v16, v162, v18
    v_dot2c_f32_bf16 v17, v178, v18
    v_dot2c_f32_bf16 v16, v163, v18
    v_dot2c_f32_bf16 v17, v179, v18
    v_mfma_f32_32x32x16_bf16 v[32:47], v[160:163], v[112:115], v[32:47]
    ds_read_b128 v[96:99], v2 offset:0
    ds_read_b64_tr_b16 v[128:129], v6 offset:0
    ds_read_b64_tr_b16 v[130:131], v6 offset:512
    ds_read_b64_tr_b16 v[144:145], v92 offset:0
    v_mfma_f32_32x32x16_bf16 v[48:63], v[176:179], v[112:115], v[48:63]
    ds_read_b64_tr_b16 v[146:147], v92 offset:512
    ds_read_b128 v[100:103], v3 offset:0
    ds_read_b64_tr_b16 v[132:133], v7 offset:0
    ds_read_b64_tr_b16 v[134:135], v7 offset:512
    v_mfma_f32_32x32x16_bf16 v[32:47], v[164:167], v[116:119], v[32:47]
    ds_read_b64_tr_b16 v[148:149], v93 offset:0
    ds_read_b64_tr_b16 v[150:151], v93 offset:512
    ds_read_b128 v[104:107], v4 offset:0
    ds_read_b64_tr_b16 v[136:137], v8 offset:0
    v_mfma_f32_32x32x16_bf16 v[48:63], v[180:183], v[116:119], v[48:63]
    s_waitcnt lgkmcnt(11)
    ds_read_b64_tr_b16 v[138:139], v8 offset:512
    ds_read_b64_tr_b16 v[152:153], v94 offset:0
    ds_read_b64_tr_b16 v[154:155], v94 offset:512
    ds_read_b128 v[108:111], v5 offset:0
    v_mfma_f32_32x32x16_bf16 v[32:47], v[168:171], v[120:123], v[32:47]
    s_waitcnt lgkmcnt(11)
    ds_read_b64_tr_b16 v[140:141], v9 offset:0
    ds_read_b64_tr_b16 v[142:143], v9 offset:512
    ds_read_b64_tr_b16 v[156:157], v95 offset:0
    ds_read_b64_tr_b16 v[158:159], v95 offset:512
    v_mfma_f32_32x32x16_bf16 v[48:63], v[184:187], v[120:123], v[48:63]
    v_mfma_f32_32x32x16_bf16 v[32:47], v[172:175], v[124:127], v[32:47]
    v_mfma_f32_32x32x16_bf16 v[48:63], v[188:191], v[124:127], v[48:63]
    s_waitcnt lgkmcnt(0)
    s_barrier
    v_dot2c_f32_bf16 v16, v128, v18
    v_dot2c_f32_bf16 v17, v144, v18
    v_dot2c_f32_bf16 v16, v129, v18
    v_dot2c_f32_bf16 v17, v145, v18
    v_dot2c_f32_bf16 v16, v130, v18
    v_dot2c_f32_bf16 v17, v146, v18
    v_dot2c_f32_bf16 v16, v131, v18
    v_dot2c_f32_bf16 v17, v147, v18
    v_mfma_f32_32x32x16_bf16 v[32:47], v[128:131], v[96:99], v[32:47]
    ds_read_b128 v[112:115], v2 offset:16384
    ds_read_b64_tr_b16 v[160:161], v6 offset:8192
    ds_read_b64_tr_b16 v[162:163], v6 offset:8704
    ds_read_b64_tr_b16 v[176:177], v92 offset:8192
    v_mfma_f32_32x32x16_bf16 v[48:63], v[144:147], v[96:99], v[48:63]
    ds_read_b64_tr_b16 v[178:179], v92 offset:8704
    ds_read_b128 v[116:119], v3 offset:16384
    ds_read_b64_tr_b16 v[164:165], v7 offset:8192
    ds_read_b64_tr_b16 v[166:167], v7 offset:8704
    v_mfma_f32_32x32x16_bf16 v[32:47], v[132:135], v[100:103], v[32:47]
    ds_read_b64_tr_b16 v[180:181], v93 offset:8192
    ds_read_b64_tr_b16 v[182:183], v93 offset:8704
    ds_read_b128 v[120:123], v4 offset:16384
    ds_read_b64_tr_b16 v[168:169], v8 offset:8192
    v_mfma_f32_32x32x16_bf16 v[48:63], v[148:151], v[100:103], v[48:63]
    s_waitcnt lgkmcnt(11)
    ds_read_b64_tr_b16 v[170:171], v8 offset:8704
    ds_read_b64_tr_b16 v[184:185], v94 offset:8192
    ds_read_b64_tr_b16 v[186:187], v94 offset:8704
    ds_read_b128 v[124:127], v5 offset:16384
    v_mfma_f32_32x32x16_bf16 v[32:47], v[136:139], v[104:107], v[32:47]
    s_waitcnt lgkmcnt(11)
    ds_read_b64_tr_b16 v[172:173], v9 offset:8192
    ds_read_b64_tr_b16 v[174:175], v9 offset:8704
    ds_read_b64_tr_b16 v[188:189], v95 offset:8192
    ds_read_b64_tr_b16 v[190:191], v95 offset:8704
    v_mfma_f32_32x32x16_bf16 v[48:63], v[152:155], v[104:107], v[48:63]
    v_mfma_f32_32x32x16_bf16 v[32:47], v[140:143], v[108:111], v[32:47]
    v_mfma_f32_32x32x16_bf16 v[48:63], v[156:159], v[108:111], v[48:63]
    s_waitcnt lgkmcnt(0)
    s_barrier
    s_mov_b32 s42, 65536
    buffer_load_dwordx2 v[14:15], v20, s[12:15], s42 offen sc1
    v_dot2c_f32_bf16 v16, v160, v18
    v_dot2c_f32_bf16 v17, v176, v18
    v_dot2c_f32_bf16 v16, v161, v18
    v_dot2c_f32_bf16 v17, v177, v18
    v_dot2c_f32_bf16 v16, v162, v18
    v_dot2c_f32_bf16 v17, v178, v18
    v_dot2c_f32_bf16 v16, v163, v18
    v_dot2c_f32_bf16 v17, v179, v18
    v_mfma_f32_32x32x16_bf16 v[32:47], v[160:163], v[112:115], v[32:47]
    ds_read_b128 v[96:99], v2 offset:32768
    ds_read_b64_tr_b16 v[128:129], v6 offset:16384
    ds_read_b64_tr_b16 v[130:131], v6 offset:16896
    ds_read_b64_tr_b16 v[144:145], v92 offset:16384
    v_mfma_f32_32x32x16_bf16 v[48:63], v[176:179], v[112:115], v[48:63]
    ds_read_b64_tr_b16 v[146:147], v92 offset:16896
    ds_read_b128 v[100:103], v3 offset:32768
    ds_read_b64_tr_b16 v[132:133], v7 offset:16384
    ds_read_b64_tr_b16 v[134:135], v7 offset:16896
    v_mfma_f32_32x32x16_bf16 v[32:47], v[164:167], v[116:119], v[32:47]
    ds_read_b64_tr_b16 v[148:149], v93 offset:16384
    ds_read_b64_tr_b16 v[150:151], v93 offset:16896
    ds_read_b128 v[104:107], v4 offset:32768
    ds_read_b64_tr_b16 v[136:137], v8 offset:16384
    v_mfma_f32_32x32x16_bf16 v[48:63], v[180:183], v[116:119], v[48:63]
    s_waitcnt lgkmcnt(11)
    ds_read_b64_tr_b16 v[138:139], v8 offset:16896
    ds_read_b64_tr_b16 v[152:153], v94 offset:16384
    ds_read_b64_tr_b16 v[154:155], v94 offset:16896
    ds_read_b128 v[108:111], v5 offset:32768
    v_mfma_f32_32x32x16_bf16 v[32:47], v[168:171], v[120:123], v[32:47]
    s_waitcnt lgkmcnt(11)
    ds_read_b64_tr_b16 v[140:141], v9 offset:16384
    ds_read_b64_tr_b16 v[142:143], v9 offset:16896
    ds_read_b64_tr_b16 v[156:157], v95 offset:16384
    ds_read_b64_tr_b16 v[158:159], v95 offset:16896
    v_mfma_f32_32x32x16_bf16 v[48:63], v[184:187], v[120:123], v[48:63]
    v_mfma_f32_32x32x16_bf16 v[32:47], v[172:175], v[124:127], v[32:47]
    v_mfma_f32_32x32x16_bf16 v[48:63], v[188:191], v[124:127], v[48:63]
    s_waitcnt lgkmcnt(0)
    s_barrier
    v_dot2c_f32_bf16 v16, v128, v18
    v_dot2c_f32_bf16 v17, v144, v18
    v_dot2c_f32_bf16 v16, v129, v18
    v_dot2c_f32_bf16 v17, v145, v18
    v_dot2c_f32_bf16 v16, v130, v18
    v_dot2c_f32_bf16 v17, v146, v18
    v_dot2c_f32_bf16 v16, v131, v18
    v_dot2c_f32_bf16 v17, v147, v18
    v_mfma_f32_32x32x16_bf16 v[32:47], v[128:131], v[96:99], v[32:47]
    ds_read_b128 v[112:115], v2 offset:49152
    ds_read_b64_tr_b16 v[160:161], v6 offset:24576
    ds_read_b64_tr_b16 v[162:163], v6 offset:25088
    ds_read_b64_tr_b16 v[176:177], v92 offset:24576
    v_mfma_f32_32x32x16_bf16 v[48:63], v[144:147], v[96:99], v[48:63]
    ds_read_b64_tr_b16 v[178:179], v92 offset:25088
    ds_read_b128 v[116:119], v3 offset:49152
    ds_read_b64_tr_b16 v[164:165], v7 offset:24576
    ds_read_b64_tr_b16 v[166:167], v7 offset:25088
    v_mfma_f32_32x32x16_bf16 v[32:47], v[132:135], v[100:103], v[32:47]
    ds_read_b64_tr_b16 v[180:181], v93 offset:24576
    ds_read_b64_tr_b16 v[182:183], v93 offset:25088
    ds_read_b128 v[120:123], v4 offset:49152
    ds_read_b64_tr_b16 v[168:169], v8 offset:24576
    v_mfma_f32_32x32x16_bf16 v[48:63], v[148:151], v[100:103], v[48:63]
    s_waitcnt lgkmcnt(11)
    ds_read_b64_tr_b16 v[170:171], v8 offset:25088
    ds_read_b64_tr_b16 v[184:185], v94 offset:24576
    ds_read_b64_tr_b16 v[186:187], v94 offset:25088
    ds_read_b128 v[124:127], v5 offset:49152
    v_mfma_f32_32x32x16_bf16 v[32:47], v[136:139], v[104:107], v[32:47]
    s_waitcnt lgkmcnt(11)
    ds_read_b64_tr_b16 v[172:173], v9 offset:24576
    ds_read_b64_tr_b16 v[174:175], v9 offset:25088
    ds_read_b64_tr_b16 v[188:189], v95 offset:24576
    ds_read_b64_tr_b16 v[190:191], v95 offset:25088
    v_mfma_f32_32x32x16_bf16 v[48:63], v[152:155], v[104:107], v[48:63]
    v_mfma_f32_32x32x16_bf16 v[32:47], v[140:143], v[108:111], v[32:47]
    v_mfma_f32_32x32x16_bf16 v[48:63], v[156:159], v[108:111], v[48:63]
    s_waitcnt lgkmcnt(0)
    s_barrier
    v_dot2c_f32_bf16 v16, v160, v18
    v_dot2c_f32_bf16 v17, v176, v18
    v_dot2c_f32_bf16 v16, v161, v18
    v_dot2c_f32_bf16 v17, v177, v18
    v_dot2c_f32_bf16 v16, v162, v18
    v_dot2c_f32_bf16 v17, v178, v18
    v_dot2c_f32_bf16 v16, v163, v18
    v_dot2c_f32_bf16 v17, v179, v18
    v_mfma_f32_32x32x16_bf16 v[32:47], v[160:163], v[112:115], v[32:47]
    ds_read_b128 v[96:99], v2 offset:0
    ds_read_b64_tr_b16 v[128:129], v6 offset:0
    ds_read_b64_tr_b16 v[130:131], v6 offset:512
    ds_read_b64_tr_b16 v[144:145], v92 offset:0
    v_mfma_f32_32x32x16_bf16 v[48:63], v[176:179], v[112:115], v[48:63]
    ds_read_b64_tr_b16 v[146:147], v92 offset:512
    ds_read_b128 v[100:103], v3 offset:0
    ds_read_b64_tr_b16 v[132:133], v7 offset:0
    ds_read_b64_tr_b16 v[134:135], v7 offset:512
    v_mfma_f32_32x32x16_bf16 v[32:47], v[164:167], v[116:119], v[32:47]
    ds_read_b64_tr_b16 v[148:149], v93 offset:0
    ds_read_b64_tr_b16 v[150:151], v93 offset:512
    ds_read_b128 v[104:107], v4 offset:0
    ds_read_b64_tr_b16 v[136:137], v8 offset:0
    v_mfma_f32_32x32x16_bf16 v[48:63], v[180:183], v[116:119], v[48:63]
    s_waitcnt lgkmcnt(11)
    ds_read_b64_tr_b16 v[138:139], v8 offset:512
    ds_read_b64_tr_b16 v[152:153], v94 offset:0
    ds_read_b64_tr_b16 v[154:155], v94 offset:512
    ds_read_b128 v[108:111], v5 offset:0
    v_mfma_f32_32x32x16_bf16 v[32:47], v[168:171], v[120:123], v[32:47]
    s_waitcnt lgkmcnt(11)
    ds_read_b64_tr_b16 v[140:141], v9 offset:0
    ds_read_b64_tr_b16 v[142:143], v9 offset:512
    ds_read_b64_tr_b16 v[156:157], v95 offset:0
    ds_read_b64_tr_b16 v[158:159], v95 offset:512
    v_mfma_f32_32x32x16_bf16 v[48:63], v[184:187], v[120:123], v[48:63]
    v_mfma_f32_32x32x16_bf16 v[32:47], v[172:175], v[124:127], v[32:47]
    v_mfma_f32_32x32x16_bf16 v[48:63], v[188:191], v[124:127], v[48:63]
    s_waitcnt lgkmcnt(0)
    s_barrier
    v_dot2c_f32_bf16 v16, v128, v18
    v_dot2c_f32_bf16 v17, v144, v18
    v_dot2c_f32_bf16 v16, v129, v18
    v_dot2c_f32_bf16 v17, v145, v18
    v_dot2c_f32_bf16 v16, v130, v18
    v_dot2c_f32_bf16 v17, v146, v18
    v_dot2c_f32_bf16 v16, v131, v18
    v_dot2c_f32_bf16 v17, v147, v18
    s_mov_b32 s42, 65536
    s_waitcnt vmcnt(0)
    s_mov_b32 s68, 0x100000
    s_branch L_tgc_4
L_tg_2:
    buffer_load_dwordx2 v[14:15], v20, s[12:15], s42 offen sc1
    s_sub_u32 s68, s68, 1
    s_waitcnt vmcnt(0)
    s_cbranch_scc1 L_tgd_3
L_tgc_4:
    v_cmp_ne_u32 vcc, s27, v15
    s_cbranch_vccnz L_tg_2
L_tgd_3:
    v_and_b32 v19, 0xffff0000, v14
    v_rcp_f32 v0, v19
    v_and_b32 v13, 0xffff, v14
    v_lshl_or_b32 v13, v13, 16, v13
    v_xor_b32 v13, 0x80008000, v13
    v_mul_f32 v0, s58, v0
    v_mfma_f32_32x32x16_bf16 v[32:47], v[128:131], v[96:99], v[32:47]
    ds_read_b128 v[112:115], v2 offset:16384
    ds_read_b64_tr_b16 v[160:161], v6 offset:8192
    ds_read_b64_tr_b16 v[162:163], v6 offset:8704
    ds_read_b64_tr_b16 v[176:177], v92 offset:8192
    v_mfma_f32_32x32x16_bf16 v[48:63], v[144:147], v[96:99], v[48:63]
    ds_read_b64_tr_b16 v[178:179], v92 offset:8704
    ds_read_b128 v[116:119], v3 offset:16384
    ds_read_b64_tr_b16 v[164:165], v7 offset:8192
    ds_read_b64_tr_b16 v[166:167], v7 offset:8704
    v_mfma_f32_32x32x16_bf16 v[32:47], v[132:135], v[100:103], v[32:47]
    ds_read_b64_tr_b16 v[180:181], v93 offset:8192
    ds_read_b64_tr_b16 v[182:183], v93 offset:8704
    ds_read_b128 v[120:123], v4 offset:16384
    ds_read_b64_tr_b16 v[168:169], v8 offset:8192
    v_mfma_f32_32x32x16_bf16 v[48:63], v[148:151], v[100:103], v[48:63]
    s_waitcnt lgkmcnt(11)
    ds_read_b64_tr_b16 v[170:171], v8 offset:8704
    ds_read_b64_tr_b16 v[184:185], v94 offset:8192
    ds_read_b64_tr_b16 v[186:187], v94 offset:8704
    ds_read_b128 v[124:127], v5 offset:16384
    v_mfma_f32_32x32x16_bf16 v[32:47], v[136:139], v[104:107], v[32:47]
    s_waitcnt lgkmcnt(11)
    ds_read_b64_tr_b16 v[172:173], v9 offset:8192
    ds_read_b64_tr_b16 v[174:175], v9 offset:8704
    ds_read_b64_tr_b16 v[188:189], v95 offset:8192
    ds_read_b64_tr_b16 v[190:191], v95 offset:8704
    v_mfma_f32_32x32x16_bf16 v[48:63], v[152:155], v[104:107], v[48:63]
    v_mfma_f32_32x32x16_bf16 v[32:47], v[140:143], v[108:111], v[32:47]
    v_mfma_f32_32x32x16_bf16 v[48:63], v[156:159], v[108:111], v[48:63]
    s_waitcnt lgkmcnt(0)
    v_dot2c_f32_bf16 v16, v160, v18
    v_dot2c_f32_bf16 v17, v176, v18
    v_dot2c_f32_bf16 v16, v161, v18
    v_dot2c_f32_bf16 v17, v177, v18
    v_dot2c_f32_bf16 v16, v162, v18
    v_dot2c_f32_bf16 v17, v178, v18
    v_dot2c_f32_bf16 v16, v163, v18
    v_dot2c_f32_bf16 v17, v179, v18
    v_mfma_f32_32x32x16_bf16 v[32:47], v[160:163], v[112:115], v[32:47]
    v_mfma_f32_32x32x16_bf16 v[48:63], v[176:179], v[112:115], v[48:63]
    v_mfma_f32_32x32x16_bf16 v[32:47], v[164:167], v[116:119], v[32:47]
    v_mfma_f32_32x32x16_bf16 v[48:63], v[180:183], v[116:119], v[48:63]
    v_mfma_f32_32x32x16_bf16 v[32:47], v[168:171], v[120:123], v[32:47]
    v_mfma_f32_32x32x16_bf16 v[48:63], v[184:187], v[120:123], v[48:63]
    v_mfma_f32_32x32x16_bf16 v[32:47], v[172:175], v[124:127], v[32:47]
    v_mfma_f32_32x32x16_bf16 v[48:63], v[188:191], v[124:127], v[48:63]
    s_nop 2
    v_cvt_pk_bf16_f32 v64, v16, v16
    v_lshlrev_b32 v64, 16, v64
    v_sub_f32 v64, v16, v64
    v_cvt_pk_bf16_f32 v65, v16, v64
    ds_write_b32 v21, v65 offset:0
    v_cvt_pk_bf16_f32 v64, v17, v17
    v_lshlrev_b32 v64, 16, v64
    v_sub_f32 v64, v17, v64
    v_cvt_pk_bf16_f32 v66, v17, v64
    ds_write_b32 v21, v66 offset:1024
    s_setprio 3
    s_waitcnt lgkmcnt(0)
    s_barrier
    ds_read_b128 v[84:87], v22
    ds_read_b128 v[88:91], v22 offset:1024
    v_mov_b32 v80, v13
    v_mov_b32 v81, v13
    v_mov_b32 v82, v13
    v_mov_b32 v83, v13
    s_nop 0
    s_waitcnt lgkmcnt(0)
    v_mfma_f32_32x32x16_bf16 v[32:47], v[84:87], v[80:83], v[32:47]
    v_mfma_f32_32x32x16_bf16 v[48:63], v[88:91], v[80:83], v[48:63]
    s_add_u32 s40, s52, s53
    s_add_u32 s41, s52, s54
    s_add_u32 s42, s41, s53
    s_nop 7
    v_pk_mul_f32 v[32:33], v[32:33], v[0:1] op_sel_hi:[1,0]
    v_pk_mul_f32 v[34:35], v[34:35], v[0:1] op_sel_hi:[1,0]
    v_pk_mul_f32 v[36:37], v[36:37], v[0:1] op_sel_hi:[1,0]
    v_pk_mul_f32 v[38:39], v[38:39], v[0:1] op_sel_hi:[1,0]
    v_pk_mul_f32 v[40:41], v[40:41], v[0:1] op_sel_hi:[1,0]
    v_pk_mul_f32 v[42:43], v[42:43], v[0:1] op_sel_hi:[1,0]
    v_pk_mul_f32 v[44:45], v[44:45], v[0:1] op_sel_hi:[1,0]
    v_pk_mul_f32 v[46:47], v[46:47], v[0:1] op_sel_hi:[1,0]
    v_cvt_pk_bf16_f32 v64, v32, v33
    v_cvt_pk_bf16_f32 v65, v34, v35
    v_cvt_pk_bf16_f32 v66, v36, v37
    v_cvt_pk_bf16_f32 v67, v38, v39
    v_cvt_pk_bf16_f32 v68, v40, v41
    v_cvt_pk_bf16_f32 v69, v42, v43
    v_cvt_pk_bf16_f32 v70, v44, v45
    v_cvt_pk_bf16_f32 v71, v46, v47
    s_cmp_lg_u32 s35, 2
    s_cbranch_scc1 L_notv_6
    v_mfma_f32_32x32x16_bf16 v[32:47], v[64:67], v[24:27], 0
    v_mfma_f32_32x32x16_bf16 v[32:47], v[68:71], v[28:31], v[32:47]
    s_nop 11
    v_cvt_pk_bf16_f32 v64, v32, v33
    v_cvt_pk_bf16_f32 v65, v34, v35
    v_cvt_pk_bf16_f32 v66, v36, v37
    v_cvt_pk_bf16_f32 v67, v38, v39
    v_cvt_pk_bf16_f32 v68, v40, v41
    v_cvt_pk_bf16_f32 v69, v42, v43
    v_cvt_pk_bf16_f32 v70, v44, v45
    v_cvt_pk_bf16_f32 v71, v46, v47
L_notv_6:
    buffer_store_dwordx4 v[64:67], v23, s[12:15], s52 offen sc1
    buffer_store_dwordx4 v[68:71], v23, s[12:15], s40 offen sc1
    v_pk_mul_f32 v[48:49], v[48:49], v[0:1] op_sel_hi:[1,0]
    v_pk_mul_f32 v[50:51], v[50:51], v[0:1] op_sel_hi:[1,0]
    v_pk_mul_f32 v[52:53], v[52:53], v[0:1] op_sel_hi:[1,0]
    v_pk_mul_f32 v[54:55], v[54:55], v[0:1] op_sel_hi:[1,0]
    v_pk_mul_f32 v[56:57], v[56:57], v[0:1] op_sel_hi:[1,0]
    v_pk_mul_f32 v[58:59], v[58:59], v[0:1] op_sel_hi:[1,0]
    v_pk_mul_f32 v[60:61], v[60:61], v[0:1] op_sel_hi:[1,0]
    v_pk_mul_f32 v[62:63], v[62:63], v[0:1] op_sel_hi:[1,0]
    v_cvt_pk_bf16_f32 v72, v48, v49
    v_cvt_pk_bf16_f32 v73, v50, v51
    v_cvt_pk_bf16_f32 v74, v52, v53
    v_cvt_pk_bf16_f32 v75, v54, v55
    v_cvt_pk_bf16_f32 v76, v56, v57
    v_cvt_pk_bf16_f32 v77, v58, v59
    v_cvt_pk_bf16_f32 v78, v60, v61
    v_cvt_pk_bf16_f32 v79, v62, v63
    s_cmp_lg_u32 s35, 2
    s_cbranch_scc1 L_notv_7
    v_mfma_f32_32x32x16_bf16 v[48:63], v[72:75], v[24:27], 0
    v_mfma_f32_32x32x16_bf16 v[48:63], v[76:79], v[28:31], v[48:63]
    s_nop 11
    v_cvt_pk_bf16_f32 v72, v48, v49
    v_cvt_pk_bf16_f32 v73, v50, v51
    v_cvt_pk_bf16_f32 v74, v52, v53
    v_cvt_pk_bf16_f32 v75, v54, v55
    v_cvt_pk_bf16_f32 v76, v56, v57
    v_cvt_pk_bf16_f32 v77, v58, v59
    v_cvt_pk_bf16_f32 v78, v60, v61
    v_cvt_pk_bf16_f32 v79, v62, v63
L_notv_7:
    buffer_store_dwordx4 v[72:75], v23, s[12:15], s41 offen sc1
    buffer_store_dwordx4 v[76:79], v23, s[12:15], s42 offen sc1
    s_waitcnt vmcnt(0)
    v_mov_b32 v254, 156972
    v_mov_b32 v255, 1
    s_add_u32 s64, s64, 0
    s_waitcnt lgkmcnt(0)
    s_mov_b64 exec, 1
    ds_add_rtn_u32 v255, v254, v255
    s_mov_b64 exec, -1
    s_waitcnt lgkmcnt(0)
    v_readfirstlane_b32 s40, v255
    s_add_u32 s40, s40, 1
    s_cmp_ge_u32 s40, 4
    s_cbranch_scc0 L_f1_8
    s_lshl_b32 s40, s28, 11
    s_lshl_b32 s41, s29, 7
    s_add_u32 s40, s40, s41
    s_lshl_b32 s41, s26, 15
    s_add_u32 s40, s40, s41
    s_add_u32 s40, s40, 655360
    v_mov_b32 v255, s27
    v_mov_b32 v254, 0
    s_mov_b64 exec, 1
    buffer_store_dword v255, v254, s[12:15], s40 offen sc1
    s_mov_b64 exec, -1
L_f1_8:
    s_lshr_b32 s42, s32, 1
    s_mul_i32 s42, s42, 5
    s_mul_i32 s43, s26, 40
    s_add_u32 s42, s42, s43
    s_and_b32 s43, s32, 1
    s_mul_i32 s69, s43, 3
    s_add_u32 s69, s69, s42
    s_lshl_b32 s69, s69, 9
    v_lshlrev_b32 v2, 4, v1
    v_add_u32 v2, s69, v2
    s_add_u32 s42, s42, 2
    s_lshl_b32 s42, s42, 9
    s_lshl_b32 s43, s43, 3
    s_add_u32 s42, s42, s43
    v_and_b32 v10, 31, v1
    v_lshlrev_b32 v4, 4, v10
    v_add_u32 v3, s42, v4
    s_mul_i32 s42, s32, 320
    s_mul_i32 s43, s26, 5120
    s_add_u32 s42, s42, s43
    s_add_u32 s42, s42, 2621440
    v_lshrrev_b32 v11, 5, v1
    v_mul_u32_u24 v5, 10240, v11
    v_add3_u32 v4, v4, v5, s42
    v_add_u32 v5, 20480, v4
    s_lshl_b32 s42, s26, 2
    s_add_u32 s42, s42, 156928
    v_mov_b32 v12, s42
    v_mov_b32 v13, 0xdddd
    s_mul_i32 s56, s25, 40960
    s_add_u32 s56, s56, 3670016
    s_add_u32 s57, s56, 2621440
    s_mul_i32 s66, s31, 163840
    s_add_u32 s66, s66, s56
    s_add_u32 s42, s25, 1
    s_and_b32 s42, s42, 3
    s_lshl_b32 s43, s31, 2
    s_add_u32 s42, s42, s43
    s_mul_i32 s42, s42, 40960
    s_add_u32 s44, s42, 1048576
    s_add_u32 s42, s25, 2
    s_and_b32 s42, s42, 3
    s_lshl_b32 s43, s31, 2
    s_add_u32 s42, s42, s43
    s_mul_i32 s42, s42, 40960
    s_add_u32 s45, s42, 1048576
    s_add_u32 s42, s25, 3
    s_and_b32 s42, s42, 3
    s_lshl_b32 s43, s31, 2
    s_add_u32 s42, s42, s43
    s_mul_i32 s42, s42, 40960
    s_add_u32 s46, s42, 1048576
    s_add_u32 s42, s25, 4
    s_and_b32 s42, s42, 3
    s_lshl_b32 s43, s31, 2
    s_add_u32 s42, s42, s43
    s_mul_i32 s42, s42, 40960
    s_add_u32 s47, s42, 1048576
    s_mul_i32 s42, s32, 20
    s_add_u32 s43, s42, 19
    s_lshr_b32 s42, s42, 6
    s_lshr_b32 s43, s43, 6
    s_sub_u32 s43, s43, s42
    v_and_b32 v15, 1, v1
    v_mul_u32_u24 v15, s43, v15
    v_add_u32 v15, s42, v15
    v_bfe_u32 v14, v1, 1, 1
    v_mul_u32_u24 v14, 5, v14
    v_add3_u32 v14, v14, v15, 5
    v_lshrrev_b32 v19, 2, v1
    v_lshl_add_u32 v14, v19, 4, v14
    v_lshlrev_b32 v14, 7, v14
    v_lshlrev_b32 v15, 7, v15
    v_mov_b32 v248, v14
    s_lshl_b32 s48, s26, 15
    s_add_u32 s48, s48, 655360
    s_lshl_b32 s49, s31, 11
    s_add_u32 s49, s49, s48
    v_mov_b32 v96, 0
    v_mov_b32 v97, 0
    v_mov_b32 v98, 0
    v_mov_b32 v99, 0
    v_mov_b32 v100, 0
    v_mov_b32 v101, 0
    v_mov_b32 v102, 0
    v_mov_b32 v103, 0
    v_mov_b32 v104, 0
    v_mov_b32 v105, 0
    v_mov_b32 v106, 0
    v_mov_b32 v107, 0
    v_mov_b32 v108, 0
    v_mov_b32 v109, 0
    v_mov_b32 v110, 0
    v_mov_b32 v111, 0
    v_mov_b32 v112, 0
    v_mov_b32 v113, 0
    v_mov_b32 v114, 0
    v_mov_b32 v115, 0
    v_mov_b32 v116, 0
    v_mov_b32 v117, 0
    v_mov_b32 v118, 0
    v_mov_b32 v119, 0
    v_mov_b32 v120, 0
    v_mov_b32 v121, 0
    v_mov_b32 v122, 0
    v_mov_b32 v123, 0
    v_mov_b32 v124, 0
    v_mov_b32 v125, 0
    v_mov_b32 v126, 0
    v_mov_b32 v127, 0
    v_mov_b32 v128, 0
    v_mov_b32 v129, 0
    v_mov_b32 v130, 0
    v_mov_b32 v131, 0
    v_mov_b32 v132, 0
    v_mov_b32 v133, 0
    v_mov_b32 v134, 0
    v_mov_b32 v135, 0
    v_mov_b32 v136, 0
    v_mov_b32 v137, 0
    v_mov_b32 v138, 0
    v_mov_b32 v139, 0
    v_mov_b32 v140, 0
    v_mov_b32 v141, 0
    v_mov_b32 v142, 0
    v_mov_b32 v143, 0
    v_mov_b32 v144, 0
    v_mov_b32 v145, 0
    v_mov_b32 v146, 0
    v_mov_b32 v147, 0
    v_mov_b32 v148, 0
    v_mov_b32 v149, 0
    v_mov_b32 v150, 0
    v_mov_b32 v151, 0
    v_mov_b32 v152, 0
    v_mov_b32 v153, 0
    v_mov_b32 v154, 0
    v_mov_b32 v155, 0
    v_mov_b32 v156, 0
    v_mov_b32 v157, 0
    v_mov_b32 v158, 0
    v_mov_b32 v159, 0
    s_mov_b32 vcc_lo, 0x100000
    s_mov_b32 vcc_hi, 0x100000
    v_mov_b32 v19, 0x3f803f80
    v_cndmask_b32 v19, 0, v19, vcc
    v_mov_b32 v172, 0x3f803f80
    v_mov_b32 v173, 0x3f80
    v_mov_b32 v164, v19
    v_mov_b32 v165, v19
    v_mov_b32 v166, v19
    v_mov_b32 v167, v19
    v_mov_b32 v168, v19
    v_mov_b32 v169, v19
    v_mov_b32 v170, v19
    v_mov_b32 v171, v19
    v_mov_b32 v188, 0x3f803f80
    v_mov_b32 v189, 0x3f80
    v_mov_b32 v180, v19
    v_mov_b32 v181, v19
    v_mov_b32 v182, v19
    v_mov_b32 v183, v19
    v_mov_b32 v184, v19
    v_mov_b32 v185, v19
    v_mov_b32 v186, v19
    v_mov_b32 v187, v19
    v_mov_b32 v204, 0x3f803f80
    v_mov_b32 v205, 0x3f80
    v_mov_b32 v196, v19
    v_mov_b32 v197, v19
    v_mov_b32 v198, v19
    v_mov_b32 v199, v19
    v_mov_b32 v200, v19
    v_mov_b32 v201, v19
    v_mov_b32 v202, v19
    v_mov_b32 v203, v19
    v_mov_b32 v220, 0x3f803f80
    v_mov_b32 v221, 0x3f80
    v_mov_b32 v212, v19
    v_mov_b32 v213, v19
    v_mov_b32 v214, v19
    v_mov_b32 v215, v19
    v_mov_b32 v216, v19
    v_mov_b32 v217, v19
    v_mov_b32 v218, v19
    v_mov_b32 v219, v19
    s_branch L_ga
L_p1b:
    s_add_u32 m0, s37, 16384
    s_lshl_b32 s40, s56, 7
    s_add_u32 s41, s40, s30
    buffer_load_dwordx4 v10, s[4:7], s41 offen lds
    s_add_u32 m0, s37, 17408
    s_add_u32 s56, s56, 1
    s_cmp_eq_u32 s56, 10
    s_cselect_b32 s56, 0, s56
    buffer_load_dwordx4 v11, s[4:7], s41 offen lds
    s_add_u32 m0, s37, 8192
    s_nop 0
    buffer_load_dwordx4 v10, s[4:7], s40 offen lds
    s_add_u32 m0, s37, 9216
    s_nop 0
    buffer_load_dwordx4 v11, s[4:7], s40 offen lds
    s_waitcnt vmcnt(6)
    s_waitcnt lgkmcnt(0)
    s_barrier
    ds_read_b128 v[96:99], v2 offset:0
    ds_read_b128 v[100:103], v3 offset:0
    ds_read_b128 v[104:107], v4 offset:0
    ds_read_b128 v[108:111], v5 offset:0
    s_add_u32 m0, s37, 32768
    s_lshl_b32 s40, s56, 7
    s_add_u32 s41, s40, s30
    buffer_load_dwordx4 v10, s[4:7], s41 offen lds
    s_add_u32 m0, s37, 33792
    s_add_u32 s56, s56, 1
    s_cmp_eq_u32 s56, 10
    s_cselect_b32 s56, 0, s56
    buffer_load_dwordx4 v11, s[4:7], s41 offen lds
    s_add_u32 m0, s37, 24576
    s_nop 0
    buffer_load_dwordx4 v10, s[4:7], s40 offen lds
    s_add_u32 m0, s37, 25600
    s_nop 0
    buffer_load_dwordx4 v11, s[4:7], s40 offen lds
    s_add_u32 m0, s37, 49152
    s_lshl_b32 s40, s56, 7
    s_add_u32 s41, s40, s30
    buffer_load_dwordx4 v10, s[4:7], s41 offen lds
    s_add_u32 m0, s37, 50176
    s_add_u32 s56, s56, 1
    s_cmp_eq_u32 s56, 10
    s_cselect_b32 s56, 0, s56
    buffer_load_dwordx4 v11, s[4:7], s41 offen lds
    s_add_u32 m0, s37, 40960
    s_nop 0
    buffer_load_dwordx4 v10, s[4:7], s40 offen lds
    s_add_u32 m0, s37, 41984
    s_nop 0
    buffer_load_dwordx4 v11, s[4:7], s40 offen lds
    s_mul_i32 s42, s59, 245760
    s_add_u32 m0, s38, 24576
    s_add_u32 s43, s42, s39
    s_add_u32 s59, s59, 1
    s_cmp_eq_u32 s59, 10
    s_cselect_b32 s59, 0, s59
    buffer_load_dwordx4 v12, s[8:11], s43 offen lds
    s_add_u32 m0, s38, 20480
    s_nop 0
    buffer_load_dwordx4 v12, s[8:11], s42 offen lds
    s_waitcnt vmcnt(10)
    s_waitcnt lgkmcnt(0)
    s_barrier
    ds_read_b128 v[112:115], v2 offset:16384
    ds_read_b128 v[116:119], v3 offset:16384
    ds_read_b128 v[120:123], v4 offset:16384
    ds_read_b128 v[124:127], v5 offset:16384
    s_add_u32 m0, s37, 0
    s_lshl_b32 s40, s56, 7
    s_add_u32 s41, s40, s30
    buffer_load_dwordx4 v10, s[4:7], s41 offen lds
    s_add_u32 m0, s37, 1024
    s_add_u32 s56, s56, 1
    s_cmp_eq_u32 s56, 10
    s_cselect_b32 s56, 0, s56
    buffer_load_dwordx4 v11, s[4:7], s41 offen lds
    s_add_u32 m0, s37, 4294959104
    s_nop 0
    buffer_load_dwordx4 v10, s[4:7], s40 offen lds
    s_add_u32 m0, s37, 4294960128
    s_nop 0
    buffer_load_dwordx4 v11, s[4:7], s40 offen lds
    s_mul_i32 s42, s59, 245760
    s_add_u32 m0, s38, 0
    s_add_u32 s43, s42, s39
    s_add_u32 s59, s59, 1
    s_cmp_eq_u32 s59, 10
    s_cselect_b32 s59, 0, s59
    buffer_load_dwordx4 v12, s[8:11], s43 offen lds
    s_add_u32 m0, s38, 4294963200
    s_nop 0
    buffer_load_dwordx4 v12, s[8:11], s42 offen lds
    s_waitcnt lgkmcnt(0)
    v_mov_b32 v19, 156960
    ds_read_b32 v19, v19
    s_waitcnt lgkmcnt(0)
    v_readfirstlane_b32 s27, v19
    s_waitcnt vmcnt(12)
    s_waitcnt lgkmcnt(0)
    s_barrier
    ds_read_b128 v[128:131], v2 offset:32768
    ds_read_b128 v[132:135], v3 offset:32768
    ds_read_b128 v[136:139], v4 offset:32768
    ds_read_b128 v[140:143], v5 offset:32768
    s_add_u32 m0, s37, 16384
    s_lshl_b32 s40, s56, 7
    s_add_u32 s41, s40, s30
    buffer_load_dwordx4 v10, s[4:7], s41 offen lds
    s_add_u32 m0, s37, 17408
    s_add_u32 s56, s56, 1
    s_cmp_eq_u32 s56, 10
    s_cselect_b32 s56, 0, s56
    buffer_load_dwordx4 v11, s[4:7], s41 offen lds
    s_add_u32 m0, s37, 8192
    s_nop 0
    buffer_load_dwordx4 v10, s[4:7], s40 offen lds
    s_add_u32 m0, s37, 9216
    s_nop 0
    buffer_load_dwordx4 v11, s[4:7], s40 offen lds
    s_mul_i32 s42, s59, 245760
    s_add_u32 m0, s38, 8192
    s_add_u32 s43, s42, s39
    s_add_u32 s59, s59, 1
    s_cmp_eq_u32 s59, 10
    s_cselect_b32 s59, 0, s59
    buffer_load_dwordx4 v12, s[8:11], s43 offen lds
    s_add_u32 m0, s38, 4096
    s_nop 0
    buffer_load_dwordx4 v12, s[8:11], s42 offen lds
    s_waitcnt vmcnt(12)
    s_waitcnt lgkmcnt(0)
    s_barrier
    ds_read_b128 v[144:147], v2 offset:49152
    ds_read_b128 v[148:151], v3 offset:49152
    ds_read_b128 v[152:155], v4 offset:49152
    ds_read_b128 v[156:159], v5 offset:49152
    s_add_u32 m0, s37, 32768
    s_lshl_b32 s40, s56, 7
    s_add_u32 s41, s40, s30
    buffer_load_dwordx4 v10, s[4:7], s41 offen lds
    s_add_u32 m0, s37, 33792
    s_add_u32 s56, s56, 1
    s_cmp_eq_u32 s56, 10
    s_cselect_b32 s56, 0, s56
    buffer_load_dwordx4 v11, s[4:7], s41 offen lds
    s_add_u32 m0, s37, 24576
    s_nop 0
    buffer_load_dwordx4 v10, s[4:7], s40 offen lds
    s_add_u32 m0, s37, 25600
    s_nop 0
    buffer_load_dwordx4 v11, s[4:7], s40 offen lds
    s_mul_i32 s42, s59, 245760
    s_add_u32 m0, s38, 16384
    s_add_u32 s43, s42, s39
    s_add_u32 s59, s59, 1
    s_cmp_eq_u32 s59, 10
    s_cselect_b32 s59, 0, s59
    buffer_load_dwordx4 v12, s[8:11], s43 offen lds
    s_add_u32 m0, s38, 12288
    s_nop 0
    buffer_load_dwordx4 v12, s[8:11], s42 offen lds
    s_waitcnt vmcnt(12)
    s_waitcnt lgkmcnt(0)
    s_barrier
    ds_read_b128 v[160:163], v2 offset:0
    ds_read_b128 v[164:167], v3 offset:0
    ds_read_b128 v[168:171], v4 offset:0
    ds_read_b128 v[172:175], v5 offset:0
    s_add_u32 m0, s37, 49152
    s_lshl_b32 s40, s56, 7
    s_add_u32 s41, s40, s30
    buffer_load_dwordx4 v10, s[4:7], s41 offen lds
    s_add_u32 m0, s37, 50176
    s_add_u32 s56, s56, 1
    s_cmp_eq_u32 s56, 10
    s_cselect_b32 s56, 0, s56
    buffer_load_dwordx4 v11, s[4:7], s41 offen lds
    s_add_u32 m0, s37, 40960
    s_nop 0
    buffer_load_dwordx4 v10, s[4:7], s40 offen lds
    s_add_u32 m0, s37, 41984
    s_nop 0
    buffer_load_dwordx4 v11, s[4:7], s40 offen lds
    s_mul_i32 s42, s59, 245760
    s_add_u32 m0, s38, 24576
    s_add_u32 s43, s42, s39
    s_add_u32 s59, s59, 1
    s_cmp_eq_u32 s59, 10
    s_cselect_b32 s59, 0, s59
    buffer_load_dwordx4 v12, s[8:11], s43 offen lds
    s_add_u32 m0, s38, 20480
    s_nop 0
    buffer_load_dwordx4 v12, s[8:11], s42 offen lds
    s_waitcnt vmcnt(12)
    s_waitcnt lgkmcnt(0)
    s_barrier
    ds_read_b128 v[176:179], v2 offset:16384
    ds_read_b128 v[180:183], v3 offset:16384
    ds_read_b128 v[184:187], v4 offset:16384
    ds_read_b128 v[188:191], v5 offset:16384
    s_add_u32 m0, s37, 0
    s_lshl_b32 s40, s56, 7
    s_add_u32 s41, s40, s30
    buffer_load_dwordx4 v10, s[4:7], s41 offen lds
    s_add_u32 m0, s37, 1024
    s_add_u32 s56, s56, 1
    s_cmp_eq_u32 s56, 10
    s_cselect_b32 s56, 0, s56
    buffer_load_dwordx4 v11, s[4:7], s41 offen lds
    s_add_u32 m0, s37, 4294959104
    s_nop 0
    buffer_load_dwordx4 v10, s[4:7], s40 offen lds
    s_add_u32 m0, s37, 4294960128
    s_nop 0
    buffer_load_dwordx4 v11, s[4:7], s40 offen lds
    s_mul_i32 s42, s59, 245760
    s_add_u32 m0, s38, 0
    s_add_u32 s43, s42, s39
    s_add_u32 s59, s59, 1
    s_cmp_eq_u32 s59, 10
    s_cselect_b32 s59, 0, s59
    buffer_load_dwordx4 v12, s[8:11], s43 offen lds
    s_add_u32 m0, s38, 4294963200
    s_nop 0
    buffer_load_dwordx4 v12, s[8:11], s42 offen lds
    s_waitcnt vmcnt(12)
    s_waitcnt lgkmcnt(0)
    s_barrier
    ds_read_b128 v[192:195], v2 offset:32768
    ds_read_b128 v[196:199], v3 offset:32768
    ds_read_b128 v[200:203], v4 offset:32768
    ds_read_b128 v[204:207], v5 offset:32768
    s_add_u32 m0, s37, 16384
    s_lshl_b32 s40, s56, 7
    s_add_u32 s41, s40, s30
    buffer_load_dwordx4 v10, s[4:7], s41 offen lds
    s_add_u32 m0, s37, 17408
    s_add_u32 s56, s56, 1
    s_cmp_eq_u32 s56, 10
    s_cselect_b32 s56, 0, s56
    buffer_load_dwordx4 v11, s[4:7], s41 offen lds
    s_add_u32 m0, s37, 8192
    s_nop 0
    buffer_load_dwordx4 v10, s[4:7], s40 offen lds
    s_add_u32 m0, s37, 9216
    s_nop 0
    buffer_load_dwordx4 v11, s[4:7], s40 offen lds
    s_mul_i32 s42, s59, 245760
    s_add_u32 m0, s38, 8192
    s_add_u32 s43, s42, s39
    s_add_u32 s59, s59, 1
    s_cmp_eq_u32 s59, 10
    s_cselect_b32 s59, 0, s59
    buffer_load_dwordx4 v12, s[8:11], s43 offen lds
    s_add_u32 m0, s38, 4096
    s_nop 0
    buffer_load_dwordx4 v12, s[8:11], s42 offen lds
    s_waitcnt vmcnt(12)
    s_waitcnt lgkmcnt(0)
    s_barrier
    ds_read_b128 v[208:211], v2 offset:49152
    ds_read_b128 v[212:215], v3 offset:49152
    ds_read_b128 v[216:219], v4 offset:49152
    ds_read_b128 v[220:223], v5 offset:49152
    s_mul_i32 s42, s57, 245760
    s_add_u32 s42, s42, 640
    s_add_u32 m0, s38, 32768
    s_add_u32 s43, s42, s39
    s_add_u32 s57, s57, 1
    s_cmp_eq_u32 s57, 10
    s_cselect_b32 s57, 0, s57
    buffer_load_dwordx4 v12, s[8:11], s43 offen lds
    s_add_u32 m0, s38, 28672
    s_nop 0
    buffer_load_dwordx4 v12, s[8:11], s42 offen lds
    s_mul_i32 s42, s57, 245760
    s_add_u32 s42, s42, 640
    s_add_u32 m0, s38, 40960
    s_add_u32 s43, s42, s39
    s_add_u32 s57, s57, 1
    s_cmp_eq_u32 s57, 10
    s_cselect_b32 s57, 0, s57
    buffer_load_dwordx4 v12, s[8:11], s43 offen lds
    s_add_u32 m0, s38, 36864
    s_nop 0
    buffer_load_dwordx4 v12, s[8:11], s42 offen lds
    s_mov_b32 s42, 65536
    buffer_load_dwordx2 v[14:15], v20, s[12:15], s42 offen sc1
    s_waitcnt vmcnt(11)
    s_waitcnt lgkmcnt(0)
    s_barrier
    ds_read_b128 v[224:227], v2 offset:0
    ds_read_b128 v[228:231], v3 offset:0
    ds_read_b128 v[232:235], v4 offset:0
    ds_read_b128 v[236:239], v5 offset:0
    s_mul_i32 s42, s57, 245760
    s_add_u32 s42, s42, 640
    s_add_u32 m0, s38, 49152
    s_add_u32 s43, s42, s39
    s_add_u32 s57, s57, 1
    s_cmp_eq_u32 s57, 10
    s_cselect_b32 s57, 0, s57
    buffer_load_dwordx4 v12, s[8:11], s43 offen lds
    s_add_u32 m0, s38, 45056
    s_nop 0
    buffer_load_dwordx4 v12, s[8:11], s42 offen lds
    s_mul_i32 s42, s57, 245760
    s_add_u32 s42, s42, 640
    s_add_u32 m0, s38, 57344
    s_add_u32 s43, s42, s39
    s_add_u32 s57, s57, 1
    s_cmp_eq_u32 s57, 10
    s_cselect_b32 s57, 0, s57
    buffer_load_dwordx4 v12, s[8:11], s43 offen lds
    s_add_u32 m0, s38, 53248
    s_nop 0
    buffer_load_dwordx4 v12, s[8:11], s42 offen lds
    s_waitcnt vmcnt(9)
    s_waitcnt lgkmcnt(0)
    s_barrier
    ds_read_b128 v[240:243], v2 offset:16384
    ds_read_b128 v[244:247], v3 offset:16384
    ds_read_b128 v[248:251], v4 offset:16384
    ds_read_b128 v[252:255], v5 offset:16384
    s_waitcnt lgkmcnt(0)
    s_barrier
    s_waitcnt vmcnt(4)
    v_mov_b32 v10, 156932
    v_mov_b32 v11, 3
    s_add_u32 s64, s64, 12
    s_waitcnt lgkmcnt(0)
    s_mov_b64 exec, 1
    ds_add_rtn_u32 v11, v10, v11
    s_mov_b64 exec, -1
    s_waitcnt lgkmcnt(0)
    v_readfirstlane_b32 s40, v11
    s_add_u32 s40, s40, 3
    s_cmp_ge_u32 s40, s64
    s_cbranch_scc1 L_gs_9
    s_mov_b32 s68, 0x2000000
L_lw_10:
    ds_read_b32 v11, v10
    s_sub_u32 s68, s68, 1
    s_cbranch_scc1 L_lwd_11
    s_waitcnt lgkmcnt(0)
    v_readfirstlane_b32 s40, v11
    s_cmp_ge_u32 s40, s64
    s_cbranch_scc1 L_lwd_11
    s_sleep 0
    s_branch L_lw_10
L_lwd_11:
    s_waitcnt lgkmcnt(0)
L_gs_9:
    s_setprio 2
    v_xor_b32 v2, 64, v6
    v_xor_b32 v3, 64, v7
    v_xor_b32 v4, 64, v8
    v_xor_b32 v5, 64, v9
    ds_read_b64_tr_b16 v[64:65], v6 offset:32768
    ds_read_b64_tr_b16 v[66:67], v6 offset:33280
    ds_read_b64_tr_b16 v[72:73], v2 offset:32768
    ds_read_b64_tr_b16 v[74:75], v2 offset:33280
    ds_read_b64_tr_b16 v[68:69], v7 offset:32768
    ds_read_b64_tr_b16 v[70:71], v7 offset:33280
    ds_read_b64_tr_b16 v[76:77], v3 offset:32768
    ds_read_b64_tr_b16 v[78:79], v3 offset:33280
    s_mul_i32 s42, s57, 245760
    s_add_u32 s42, s42, 640
    s_add_u32 m0, s38, 4294934528
    s_add_u32 s43, s42, s39
    s_add_u32 s57, s57, 1
    s_cmp_eq_u32 s57, 10
    s_cselect_b32 s57, 0, s57
    buffer_load_dwordx4 v12, s[8:11], s43 offen lds
    s_add_u32 m0, s38, 4294930432
    s_nop 0
    buffer_load_dwordx4 v12, s[8:11], s42 offen lds
    s_mul_i32 s42, s57, 245760
    s_add_u32 s42, s42, 640
    s_add_u32 m0, s38, 4294942720
    s_add_u32 s43, s42, s39
    s_add_u32 s57, s57, 1
    s_cmp_eq_u32 s57, 10
    s_cselect_b32 s57, 0, s57
    buffer_load_dwordx4 v12, s[8:11], s43 offen lds
    s_add_u32 m0, s38, 4294938624
    s_nop 0
    buffer_load_dwordx4 v12, s[8:11], s42 offen lds
    s_mov_b32 s42, 65536
    s_mov_b32 s68, 0x100000
    s_branch L_tgc_14
L_tg_12:
    buffer_load_dwordx2 v[14:15], v20, s[12:15], s42 offen sc1
    s_sub_u32 s68, s68, 1
    s_waitcnt vmcnt(0)
    s_cbranch_scc1 L_tgd_13
L_tgc_14:
    v_cmp_ne_u32 vcc, s27, v15
    s_cbranch_vccnz L_tg_12
L_tgd_13:
    v_and_b32 v19, 0xffff0000, v14
    v_rcp_f32 v0, v19
    v_and_b32 v13, 0xffff, v14
    v_lshl_or_b32 v13, v13, 16, v13
    v_xor_b32 v13, 0x80008000, v13
    v_mul_f32 v0, s58, v0
    s_waitcnt lgkmcnt(0)
    v_dot2c_f32_bf16 v16, v64, v18
    v_dot2c_f32_bf16 v17, v72, v18
    v_dot2c_f32_bf16 v16, v65, v18
    v_dot2c_f32_bf16 v17, v73, v18
    v_dot2c_f32_bf16 v16, v66, v18
    v_dot2c_f32_bf16 v17, v74, v18
    v_dot2c_f32_bf16 v16, v67, v18
    v_dot2c_f32_bf16 v17, v75, v18
    v_mfma_f32_32x32x16_bf16 v[32:47], v[64:67], v[96:99], 0
    ds_read_b64_tr_b16 v[80:81], v8 offset:32768
    ds_read_b64_tr_b16 v[82:83], v8 offset:33280
    ds_read_b64_tr_b16 v[88:89], v4 offset:32768
    ds_read_b64_tr_b16 v[90:91], v4 offset:33280
    s_mul_i32 s42, s57, 245760
    s_add_u32 s42, s42, 640
    s_add_u32 m0, s38, 4294950912
    s_add_u32 s43, s42, s39
    s_add_u32 s57, s57, 1
    s_cmp_eq_u32 s57, 10
    s_cselect_b32 s57, 0, s57
    buffer_load_dwordx4 v12, s[8:11], s43 offen lds
    v_mfma_f32_32x32x16_bf16 v[48:63], v[72:75], v[96:99], 0
    ds_read_b64_tr_b16 v[84:85], v9 offset:32768
    ds_read_b64_tr_b16 v[86:87], v9 offset:33280
    ds_read_b64_tr_b16 v[92:93], v5 offset:32768
    ds_read_b64_tr_b16 v[94:95], v5 offset:33280
    s_add_u32 m0, s38, 4294946816
    s_nop 0
    buffer_load_dwordx4 v12, s[8:11], s42 offen lds
    v_mfma_f32_32x32x16_bf16 v[32:47], v[68:71], v[100:103], v[32:47]
    v_mfma_f32_32x32x16_bf16 v[48:63], v[76:79], v[100:103], v[48:63]
    s_waitcnt lgkmcnt(0)
    v_mfma_f32_32x32x16_bf16 v[32:47], v[80:83], v[104:107], v[32:47]
    ds_read_b64_tr_b16 v[64:65], v6 offset:40960
    ds_read_b64_tr_b16 v[66:67], v6 offset:41472
    ds_read_b64_tr_b16 v[72:73], v2 offset:40960
    ds_read_b64_tr_b16 v[74:75], v2 offset:41472
    s_mul_i32 s42, s57, 245760
    s_add_u32 s42, s42, 640
    s_add_u32 m0, s38, 4294959104
    s_add_u32 s43, s42, s39
    s_add_u32 s57, s57, 1
    s_cmp_eq_u32 s57, 10
    s_cselect_b32 s57, 0, s57
    buffer_load_dwordx4 v12, s[8:11], s43 offen lds
    v_mfma_f32_32x32x16_bf16 v[48:63], v[88:91], v[104:107], v[48:63]
    ds_read_b64_tr_b16 v[68:69], v7 offset:40960
    ds_read_b64_tr_b16 v[70:71], v7 offset:41472
    ds_read_b64_tr_b16 v[76:77], v3 offset:40960
    ds_read_b64_tr_b16 v[78:79], v3 offset:41472
    s_add_u32 m0, s38, 4294955008
    s_nop 0
    buffer_load_dwordx4 v12, s[8:11], s42 offen lds
    v_mfma_f32_32x32x16_bf16 v[32:47], v[84:87], v[108:111], v[32:47]
    v_mfma_f32_32x32x16_bf16 v[48:63], v[92:95], v[108:111], v[48:63]
    s_waitcnt vmcnt(8)
    v_mov_b32 v10, 156964
    v_mov_b32 v11, 1
    s_waitcnt lgkmcnt(0)
    s_mov_b64 exec, 1
    ds_add_u32 v10, v11
    s_mov_b64 exec, -1
    s_waitcnt lgkmcnt(0)
    v_dot2c_f32_bf16 v16, v64, v18
    v_dot2c_f32_bf16 v17, v72, v18
    v_dot2c_f32_bf16 v16, v65, v18
    v_dot2c_f32_bf16 v17, v73, v18
    v_dot2c_f32_bf16 v16, v66, v18
    v_dot2c_f32_bf16 v17, v74, v18
    v_dot2c_f32_bf16 v16, v67, v18
    v_dot2c_f32_bf16 v17, v75, v18
    v_mfma_f32_32x32x16_bf16 v[32:47], v[64:67], v[112:115], v[32:47]
    ds_read_b64_tr_b16 v[80:81], v8 offset:40960
    ds_read_b64_tr_b16 v[82:83], v8 offset:41472
    ds_read_b64_tr_b16 v[88:89], v4 offset:40960
    ds_read_b64_tr_b16 v[90:91], v4 offset:41472
    s_mul_i32 s42, s57, 245760
    s_add_u32 s42, s42, 640
    s_add_u32 m0, s38, 4294901760
    s_add_u32 s43, s42, s39
    s_add_u32 s57, s57, 1
    s_cmp_eq_u32 s57, 10
    s_cselect_b32 s57, 0, s57
    buffer_load_dwordx4 v12, s[8:11], s43 offen lds
    v_mfma_f32_32x32x16_bf16 v[48:63], v[72:75], v[112:115], v[48:63]
    ds_read_b64_tr_b16 v[84:85], v9 offset:40960
    ds_read_b64_tr_b16 v[86:87], v9 offset:41472
    ds_read_b64_tr_b16 v[92:93], v5 offset:40960
    ds_read_b64_tr_b16 v[94:95], v5 offset:41472
    s_add_u32 m0, s38, 4294897664
    s_nop 0
    buffer_load_dwordx4 v12, s[8:11], s42 offen lds
    v_mfma_f32_32x32x16_bf16 v[32:47], v[68:71], v[116:119], v[32:47]
    v_mfma_f32_32x32x16_bf16 v[48:63], v[76:79], v[116:119], v[48:63]
    v_mov_b32 v10, 156964
    s_mov_b32 s68, 0x2000000
L_lw_15:
    ds_read_b32 v11, v10
    s_sub_u32 s68, s68, 1
    s_cbranch_scc1 L_lwd_16
    s_waitcnt lgkmcnt(0)
    v_readfirstlane_b32 s40, v11
    s_cmp_ge_u32 s40, 4
    s_cbranch_scc1 L_lwd_16
    s_sleep 0
    s_branch L_lw_15
L_lwd_16:
    s_waitcnt lgkmcnt(0)
    s_waitcnt lgkmcnt(0)
    v_mfma_f32_32x32x16_bf16 v[32:47], v[80:83], v[120:123], v[32:47]
    ds_read_b64_tr_b16 v[64:65], v6 offset:49152
    ds_read_b64_tr_b16 v[66:67], v6 offset:49664
    ds_read_b64_tr_b16 v[72:73], v2 offset:49152
    ds_read_b64_tr_b16 v[74:75], v2 offset:49664
    s_mul_i32 s42, s57, 245760
    s_add_u32 s42, s42, 640
    s_add_u32 m0, s38, 4294909952
    s_add_u32 s43, s42, s39
    s_add_u32 s57, s57, 1
    s_cmp_eq_u32 s57, 10
    s_cselect_b32 s57, 0, s57
    buffer_load_dwordx4 v12, s[8:11], s43 offen lds
    v_mfma_f32_32x32x16_bf16 v[48:63], v[88:91], v[120:123], v[48:63]
    ds_read_b64_tr_b16 v[68:69], v7 offset:49152
    ds_read_b64_tr_b16 v[70:71], v7 offset:49664
    ds_read_b64_tr_b16 v[76:77], v3 offset:49152
    ds_read_b64_tr_b16 v[78:79], v3 offset:49664
    s_add_u32 m0, s38, 4294905856
    s_nop 0
    buffer_load_dwordx4 v12, s[8:11], s42 offen lds
    v_mfma_f32_32x32x16_bf16 v[32:47], v[84:87], v[124:127], v[32:47]
    v_mfma_f32_32x32x16_bf16 v[48:63], v[92:95], v[124:127], v[48:63]
    s_waitcnt lgkmcnt(0)
    v_dot2c_f32_bf16 v16, v64, v18
    v_dot2c_f32_bf16 v17, v72, v18
    v_dot2c_f32_bf16 v16, v65, v18
    v_dot2c_f32_bf16 v17, v73, v18
    v_dot2c_f32_bf16 v16, v66, v18
    v_dot2c_f32_bf16 v17, v74, v18
    v_dot2c_f32_bf16 v16, v67, v18
    v_dot2c_f32_bf16 v17, v75, v18
    v_mfma_f32_32x32x16_bf16 v[32:47], v[64:67], v[128:131], v[32:47]
    ds_read_b64_tr_b16 v[80:81], v8 offset:49152
    ds_read_b64_tr_b16 v[82:83], v8 offset:49664
    ds_read_b64_tr_b16 v[88:89], v4 offset:49152
    ds_read_b64_tr_b16 v[90:91], v4 offset:49664
    v_mfma_f32_32x32x16_bf16 v[48:63], v[72:75], v[128:131], v[48:63]
    ds_read_b64_tr_b16 v[84:85], v9 offset:49152
    ds_read_b64_tr_b16 v[86:87], v9 offset:49664
    ds_read_b64_tr_b16 v[92:93], v5 offset:49152
    ds_read_b64_tr_b16 v[94:95], v5 offset:49664
    v_mfma_f32_32x32x16_bf16 v[32:47], v[68:71], v[132:135], v[32:47]
    v_mfma_f32_32x32x16_bf16 v[48:63], v[76:79], v[132:135], v[48:63]
    s_waitcnt lgkmcnt(0)
    v_mfma_f32_32x32x16_bf16 v[32:47], v[80:83], v[136:139], v[32:47]
    ds_read_b64_tr_b16 v[64:65], v6 offset:57344
    ds_read_b64_tr_b16 v[66:67], v6 offset:57856
    ds_read_b64_tr_b16 v[72:73], v2 offset:57344
    ds_read_b64_tr_b16 v[74:75], v2 offset:57856
    v_mfma_f32_32x32x16_bf16 v[48:63], v[88:91], v[136:139], v[48:63]
    ds_read_b64_tr_b16 v[68:69], v7 offset:57344
    ds_read_b64_tr_b16 v[70:71], v7 offset:57856
    ds_read_b64_tr_b16 v[76:77], v3 offset:57344
    ds_read_b64_tr_b16 v[78:79], v3 offset:57856
    v_mfma_f32_32x32x16_bf16 v[32:47], v[84:87], v[140:143], v[32:47]
    v_mfma_f32_32x32x16_bf16 v[48:63], v[92:95], v[140:143], v[48:63]
    s_waitcnt vmcnt(6)
    v_mov_b32 v10, 156964
    v_mov_b32 v11, 1
    s_waitcnt lgkmcnt(0)
    s_mov_b64 exec, 1
    ds_add_u32 v10, v11
    s_mov_b64 exec, -1
    s_waitcnt lgkmcnt(0)
    v_dot2c_f32_bf16 v16, v64, v18
    v_dot2c_f32_bf16 v17, v72, v18
    v_dot2c_f32_bf16 v16, v65, v18
    v_dot2c_f32_bf16 v17, v73, v18
    v_dot2c_f32_bf16 v16, v66, v18
    v_dot2c_f32_bf16 v17, v74, v18
    v_dot2c_f32_bf16 v16, v67, v18
    v_dot2c_f32_bf16 v17, v75, v18
    v_mfma_f32_32x32x16_bf16 v[32:47], v[64:67], v[144:147], v[32:47]
    ds_read_b64_tr_b16 v[80:81], v8 offset:57344
    ds_read_b64_tr_b16 v[82:83], v8 offset:57856
    ds_read_b64_tr_b16 v[88:89], v4 offset:57344
    ds_read_b64_tr_b16 v[90:91], v4 offset:57856
    v_mfma_f32_32x32x16_bf16 v[48:63], v[72:75], v[144:147], v[48:63]
    ds_read_b64_tr_b16 v[84:85], v9 offset:57344
    ds_read_b64_tr_b16 v[86:87], v9 offset:57856
    ds_read_b64_tr_b16 v[92:93], v5 offset:57344
    ds_read_b64_tr_b16 v[94:95], v5 offset:57856
    v_mfma_f32_32x32x16_bf16 v[32:47], v[68:71], v[148:151], v[32:47]
    v_mfma_f32_32x32x16_bf16 v[48:63], v[76:79], v[148:151], v[48:63]
    v_mov_b32 v10, 156964
    s_mov_b32 s68, 0x2000000
L_lw_17:
    ds_read_b32 v11, v10
    s_sub_u32 s68, s68, 1
    s_cbranch_scc1 L_lwd_18
    s_waitcnt lgkmcnt(0)
    v_readfirstlane_b32 s40, v11
    s_cmp_ge_u32 s40, 8
    s_cbranch_scc1 L_lwd_18
    s_sleep 0
    s_branch L_lw_17
L_lwd_18:
    s_waitcnt lgkmcnt(0)
    v_subrev_u32 v6, 65536, v6
    v_subrev_u32 v2, 65536, v2
    v_subrev_u32 v7, 65536, v7
    v_subrev_u32 v3, 65536, v3
    v_subrev_u32 v8, 65536, v8
    v_subrev_u32 v4, 65536, v4
    v_subrev_u32 v9, 65536, v9
    v_subrev_u32 v5, 65536, v5
    s_waitcnt lgkmcnt(0)
    v_mfma_f32_32x32x16_bf16 v[32:47], v[80:83], v[152:155], v[32:47]
    ds_read_b64_tr_b16 v[64:65], v6 offset:32768
    ds_read_b64_tr_b16 v[66:67], v6 offset:33280
    ds_read_b64_tr_b16 v[72:73], v2 offset:32768
    ds_read_b64_tr_b16 v[74:75], v2 offset:33280
    v_mfma_f32_32x32x16_bf16 v[48:63], v[88:91], v[152:155], v[48:63]
    ds_read_b64_tr_b16 v[68:69], v7 offset:32768
    ds_read_b64_tr_b16 v[70:71], v7 offset:33280
    ds_read_b64_tr_b16 v[76:77], v3 offset:32768
    ds_read_b64_tr_b16 v[78:79], v3 offset:33280
    v_mfma_f32_32x32x16_bf16 v[32:47], v[84:87], v[156:159], v[32:47]
    v_mfma_f32_32x32x16_bf16 v[48:63], v[92:95], v[156:159], v[48:63]
    s_waitcnt lgkmcnt(0)
    v_dot2c_f32_bf16 v16, v64, v18
    v_dot2c_f32_bf16 v17, v72, v18
    v_dot2c_f32_bf16 v16, v65, v18
    v_dot2c_f32_bf16 v17, v73, v18
    v_dot2c_f32_bf16 v16, v66, v18
    v_dot2c_f32_bf16 v17, v74, v18
    v_dot2c_f32_bf16 v16, v67, v18
    v_dot2c_f32_bf16 v17, v75, v18
    v_mfma_f32_32x32x16_bf16 v[32:47], v[64:67], v[160:163], v[32:47]
    ds_read_b64_tr_b16 v[80:81], v8 offset:32768
    ds_read_b64_tr_b16 v[82:83], v8 offset:33280
    ds_read_b64_tr_b16 v[88:89], v4 offset:32768
    ds_read_b64_tr_b16 v[90:91], v4 offset:33280
    v_mov_b32 v96, 0
    v_mov_b32 v97, 0
    v_mov_b32 v98, 0
    v_mov_b32 v99, 0
    v_mfma_f32_32x32x16_bf16 v[48:63], v[72:75], v[160:163], v[48:63]
    ds_read_b64_tr_b16 v[84:85], v9 offset:32768
    ds_read_b64_tr_b16 v[86:87], v9 offset:33280
    ds_read_b64_tr_b16 v[92:93], v5 offset:32768
    ds_read_b64_tr_b16 v[94:95], v5 offset:33280
    v_mov_b32 v100, 0
    v_mov_b32 v101, 0
    v_mov_b32 v102, 0
    v_mov_b32 v103, 0
    v_mfma_f32_32x32x16_bf16 v[32:47], v[68:71], v[164:167], v[32:47]
    v_mov_b32 v104, 0
    v_mov_b32 v105, 0
    v_mov_b32 v106, 0
    v_mov_b32 v107, 0
    v_mfma_f32_32x32x16_bf16 v[48:63], v[76:79], v[164:167], v[48:63]
    v_mov_b32 v108, 0
    v_mov_b32 v109, 0
    v_mov_b32 v110, 0
    v_mov_b32 v111, 0
    s_waitcnt lgkmcnt(0)
    v_mfma_f32_32x32x16_bf16 v[32:47], v[80:83], v[168:171], v[32:47]
    ds_read_b64_tr_b16 v[64:65], v6 offset:40960
    ds_read_b64_tr_b16 v[66:67], v6 offset:41472
    ds_read_b64_tr_b16 v[72:73], v2 offset:40960
    ds_read_b64_tr_b16 v[74:75], v2 offset:41472
    v_mov_b32 v112, 0
    v_mov_b32 v113, 0
    v_mov_b32 v114, 0
    v_mov_b32 v115, 0
    v_mfma_f32_32x32x16_bf16 v[48:63], v[88:91], v[168:171], v[48:63]
    ds_read_b64_tr_b16 v[68:69], v7 offset:40960
    ds_read_b64_tr_b16 v[70:71], v7 offset:41472
    ds_read_b64_tr_b16 v[76:77], v3 offset:40960
    ds_read_b64_tr_b16 v[78:79], v3 offset:41472
    v_mov_b32 v116, 0
    v_mov_b32 v117, 0
    v_mov_b32 v118, 0
    v_mov_b32 v119, 0
    v_mfma_f32_32x32x16_bf16 v[32:47], v[84:87], v[172:175], v[32:47]
    v_mov_b32 v120, 0
    v_mov_b32 v121, 0
    v_mov_b32 v122, 0
    v_mov_b32 v123, 0
    v_mfma_f32_32x32x16_bf16 v[48:63], v[92:95], v[172:175], v[48:63]
    v_mov_b32 v124, 0
    v_mov_b32 v125, 0
    v_mov_b32 v126, 0
    v_mov_b32 v127, 0
    s_waitcnt lgkmcnt(0)
    v_dot2c_f32_bf16 v16, v64, v18
    v_dot2c_f32_bf16 v17, v72, v18
    v_dot2c_f32_bf16 v16, v65, v18
    v_dot2c_f32_bf16 v17, v73, v18
    v_dot2c_f32_bf16 v16, v66, v18
    v_dot2c_f32_bf16 v17, v74, v18
    v_dot2c_f32_bf16 v16, v67, v18
    v_dot2c_f32_bf16 v17, v75, v18
    v_mfma_f32_32x32x16_bf16 v[32:47], v[64:67], v[176:179], v[32:47]
    ds_read_b64_tr_b16 v[80:81], v8 offset:40960
    ds_read_b64_tr_b16 v[82:83], v8 offset:41472
    ds_read_b64_tr_b16 v[88:89], v4 offset:40960
    ds_read_b64_tr_b16 v[90:91], v4 offset:41472
    v_mov_b32 v128, 0
    v_mov_b32 v129, 0
    v_mov_b32 v130, 0
    v_mov_b32 v131, 0
    v_mfma_f32_32x32x16_bf16 v[48:63], v[72:75], v[176:179], v[48:63]
    ds_read_b64_tr_b16 v[84:85], v9 offset:40960
    ds_read_b64_tr_b16 v[86:87], v9 offset:41472
    ds_read_b64_tr_b16 v[92:93], v5 offset:40960
    ds_read_b64_tr_b16 v[94:95], v5 offset:41472
    v_mov_b32 v132, 0
    v_mov_b32 v133, 0
    v_mov_b32 v134, 0
    v_mov_b32 v135, 0
    v_mfma_f32_32x32x16_bf16 v[32:47], v[68:71], v[180:183], v[32:47]
    v_mov_b32 v136, 0
    v_mov_b32 v137, 0
    v_mov_b32 v138, 0
    v_mov_b32 v139, 0
    v_mfma_f32_32x32x16_bf16 v[48:63], v[76:79], v[180:183], v[48:63]
    v_mov_b32 v140, 0
    v_mov_b32 v141, 0
    v_mov_b32 v142, 0
    v_mov_b32 v143, 0
    s_waitcnt lgkmcnt(0)
    v_mfma_f32_32x32x16_bf16 v[32:47], v[80:83], v[184:187], v[32:47]
    ds_read_b64_tr_b16 v[64:65], v6 offset:49152
    ds_read_b64_tr_b16 v[66:67], v6 offset:49664
    ds_read_b64_tr_b16 v[72:73], v2 offset:49152
    ds_read_b64_tr_b16 v[74:75], v2 offset:49664
    v_mov_b32 v144, 0
    v_mov_b32 v145, 0
    v_mov_b32 v146, 0
    v_mov_b32 v147, 0
    v_mfma_f32_32x32x16_bf16 v[48:63], v[88:91], v[184:187], v[48:63]
    ds_read_b64_tr_b16 v[68:69], v7 offset:49152
    ds_read_b64_tr_b16 v[70:71], v7 offset:49664
    ds_read_b64_tr_b16 v[76:77], v3 offset:49152
    ds_read_b64_tr_b16 v[78:79], v3 offset:49664
    v_mov_b32 v148, 0
    v_mov_b32 v149, 0
    v_mov_b32 v150, 0
    v_mov_b32 v151, 0
    v_mfma_f32_32x32x16_bf16 v[32:47], v[84:87], v[188:191], v[32:47]
    v_mov_b32 v152, 0
    v_mov_b32 v153, 0
    v_mov_b32 v154, 0
    v_mov_b32 v155, 0
    v_mfma_f32_32x32x16_bf16 v[48:63], v[92:95], v[188:191], v[48:63]
    v_mov_b32 v156, 0
    v_mov_b32 v157, 0
    v_mov_b32 v158, 0
    v_mov_b32 v159, 0
    s_waitcnt vmcnt(0)
    v_mov_b32 v10, 156964
    v_mov_b32 v11, 1
    s_waitcnt lgkmcnt(0)
    s_mov_b64 exec, 1
    ds_add_u32 v10, v11
    s_mov_b64 exec, -1
    s_waitcnt lgkmcnt(0)
    v_dot2c_f32_bf16 v16, v64, v18
    v_dot2c_f32_bf16 v17, v72, v18
    v_dot2c_f32_bf16 v16, v65, v18
    v_dot2c_f32_bf16 v17, v73, v18
    v_dot2c_f32_bf16 v16, v66, v18
    v_dot2c_f32_bf16 v17, v74, v18
    v_dot2c_f32_bf16 v16, v67, v18
    v_dot2c_f32_bf16 v17, v75, v18
    v_mfma_f32_32x32x16_bf16 v[32:47], v[64:67], v[192:195], v[32:47]
    ds_read_b64_tr_b16 v[80:81], v8 offset:49152
    ds_read_b64_tr_b16 v[82:83], v8 offset:49664
    ds_read_b64_tr_b16 v[88:89], v4 offset:49152
    ds_read_b64_tr_b16 v[90:91], v4 offset:49664
    v_mfma_f32_32x32x16_bf16 v[48:63], v[72:75], v[192:195], v[48:63]
    ds_read_b64_tr_b16 v[84:85], v9 offset:49152
    ds_read_b64_tr_b16 v[86:87], v9 offset:49664
    ds_read_b64_tr_b16 v[92:93], v5 offset:49152
    ds_read_b64_tr_b16 v[94:95], v5 offset:49664
    v_mfma_f32_32x32x16_bf16 v[32:47], v[68:71], v[196:199], v[32:47]
    v_mfma_f32_32x32x16_bf16 v[48:63], v[76:79], v[196:199], v[48:63]
    v_mov_b32 v10, 156964
    s_mov_b32 s68, 0x2000000
L_lw_19:
    ds_read_b32 v11, v10
    s_sub_u32 s68, s68, 1
    s_cbranch_scc1 L_lwd_20
    s_waitcnt lgkmcnt(0)
    v_readfirstlane_b32 s40, v11
    s_cmp_ge_u32 s40, 12
    s_cbranch_scc1 L_lwd_20
    s_sleep 0
    s_branch L_lw_19
L_lwd_20:
    s_waitcnt lgkmcnt(0)
    s_waitcnt lgkmcnt(0)
    v_mfma_f32_32x32x16_bf16 v[32:47], v[80:83], v[200:203], v[32:47]
    ds_read_b64_tr_b16 v[64:65], v6 offset:57344
    ds_read_b64_tr_b16 v[66:67], v6 offset:57856
    ds_read_b64_tr_b16 v[72:73], v2 offset:57344
    ds_read_b64_tr_b16 v[74:75], v2 offset:57856
    v_mfma_f32_32x32x16_bf16 v[48:63], v[88:91], v[200:203], v[48:63]
    ds_read_b64_tr_b16 v[68:69], v7 offset:57344
    ds_read_b64_tr_b16 v[70:71], v7 offset:57856
    ds_read_b64_tr_b16 v[76:77], v3 offset:57344
    ds_read_b64_tr_b16 v[78:79], v3 offset:57856
    v_mfma_f32_32x32x16_bf16 v[32:47], v[84:87], v[204:207], v[32:47]
    v_mfma_f32_32x32x16_bf16 v[48:63], v[92:95], v[204:207], v[48:63]
    s_waitcnt lgkmcnt(0)
    v_dot2c_f32_bf16 v16, v64, v18
    v_dot2c_f32_bf16 v17, v72, v18
    v_dot2c_f32_bf16 v16, v65, v18
    v_dot2c_f32_bf16 v17, v73, v18
    v_dot2c_f32_bf16 v16, v66, v18
    v_dot2c_f32_bf16 v17, v74, v18
    v_dot2c_f32_bf16 v16, v67, v18
    v_dot2c_f32_bf16 v17, v75, v18
    v_mfma_f32_32x32x16_bf16 v[32:47], v[64:67], v[208:211], v[32:47]
    ds_read_b64_tr_b16 v[80:81], v8 offset:57344
    ds_read_b64_tr_b16 v[82:83], v8 offset:57856
    ds_read_b64_tr_b16 v[88:89], v4 offset:57344
    ds_read_b64_tr_b16 v[90:91], v4 offset:57856
    v_mfma_f32_32x32x16_bf16 v[48:63], v[72:75], v[208:211], v[48:63]
    ds_read_b64_tr_b16 v[84:85], v9 offset:57344
    ds_read_b64_tr_b16 v[86:87], v9 offset:57856
    ds_read_b64_tr_b16 v[92:93], v5 offset:57344
    ds_read_b64_tr_b16 v[94:95], v5 offset:57856
    v_mfma_f32_32x32x16_bf16 v[32:47], v[68:71], v[212:215], v[32:47]
    v_mfma_f32_32x32x16_bf16 v[48:63], v[76:79], v[212:215], v[48:63]
    s_waitcnt lgkmcnt(0)
    v_mfma_f32_32x32x16_bf16 v[32:47], v[80:83], v[216:219], v[32:47]
    ds_read_b64_tr_b16 v[64:65], v6 offset:0
    ds_read_b64_tr_b16 v[66:67], v6 offset:512
    ds_read_b64_tr_b16 v[72:73], v2 offset:0
    ds_read_b64_tr_b16 v[74:75], v2 offset:512
    v_mfma_f32_32x32x16_bf16 v[48:63], v[88:91], v[216:219], v[48:63]
    ds_read_b64_tr_b16 v[68:69], v7 offset:0
    ds_read_b64_tr_b16 v[70:71], v7 offset:512
    ds_read_b64_tr_b16 v[76:77], v3 offset:0
    ds_read_b64_tr_b16 v[78:79], v3 offset:512
    v_mfma_f32_32x32x16_bf16 v[32:47], v[84:87], v[220:223], v[32:47]
    v_mfma_f32_32x32x16_bf16 v[48:63], v[92:95], v[220:223], v[48:63]
    s_waitcnt lgkmcnt(0)
    v_dot2c_f32_bf16 v16, v64, v18
    v_dot2c_f32_bf16 v17, v72, v18
    v_dot2c_f32_bf16 v16, v65, v18
    v_dot2c_f32_bf16 v17, v73, v18
    v_dot2c_f32_bf16 v16, v66, v18
    v_dot2c_f32_bf16 v17, v74, v18
    v_dot2c_f32_bf16 v16, v67, v18
    v_dot2c_f32_bf16 v17, v75, v18
    v_mfma_f32_32x32x16_bf16 v[32:47], v[64:67], v[224:227], v[32:47]
    ds_read_b64_tr_b16 v[80:81], v8 offset:0
    ds_read_b64_tr_b16 v[82:83], v8 offset:512
    ds_read_b64_tr_b16 v[88:89], v4 offset:0
    ds_read_b64_tr_b16 v[90:91], v4 offset:512
    s_mov_b32 vcc_lo, 0x100000
    s_mov_b32 vcc_hi, 0x100000
    v_mov_b32 v19, 0x3f803f80
    v_cndmask_b32 v19, 0, v19, vcc
    v_mfma_f32_32x32x16_bf16 v[48:63], v[72:75], v[224:227], v[48:63]
    ds_read_b64_tr_b16 v[84:85], v9 offset:0
    ds_read_b64_tr_b16 v[86:87], v9 offset:512
    ds_read_b64_tr_b16 v[92:93], v5 offset:0
    ds_read_b64_tr_b16 v[94:95], v5 offset:512
    v_mov_b32 v172, 0x3f803f80
    v_mov_b32 v173, 0x3f80
    v_mov_b32 v164, v19
    v_mov_b32 v165, v19
    v_mfma_f32_32x32x16_bf16 v[32:47], v[68:71], v[228:231], v[32:47]
    v_mov_b32 v166, v19
    v_mov_b32 v167, v19
    v_mov_b32 v168, v19
    v_mov_b32 v169, v19
    v_mfma_f32_32x32x16_bf16 v[48:63], v[76:79], v[228:231], v[48:63]
    v_mov_b32 v170, v19
    v_mov_b32 v171, v19
    s_waitcnt lgkmcnt(0)
    v_mfma_f32_32x32x16_bf16 v[32:47], v[80:83], v[232:235], v[32:47]
    ds_read_b64_tr_b16 v[64:65], v6 offset:8192
    ds_read_b64_tr_b16 v[66:67], v6 offset:8704
    ds_read_b64_tr_b16 v[72:73], v2 offset:8192
    ds_read_b64_tr_b16 v[74:75], v2 offset:8704
    s_mov_b32 vcc_lo, 0x100000
    s_mov_b32 vcc_hi, 0x100000
    v_mov_b32 v19, 0x3f803f80
    v_cndmask_b32 v19, 0, v19, vcc
    v_mfma_f32_32x32x16_bf16 v[48:63], v[88:91], v[232:235], v[48:63]
    ds_read_b64_tr_b16 v[68:69], v7 offset:8192
    ds_read_b64_tr_b16 v[70:71], v7 offset:8704
    ds_read_b64_tr_b16 v[76:77], v3 offset:8192
    ds_read_b64_tr_b16 v[78:79], v3 offset:8704
    v_mov_b32 v188, 0x3f803f80
    v_mov_b32 v189, 0x3f80
    v_mov_b32 v180, v19
    v_mov_b32 v181, v19
    v_mfma_f32_32x32x16_bf16 v[32:47], v[84:87], v[236:239], v[32:47]
    v_mov_b32 v182, v19
    v_mov_b32 v183, v19
    v_mov_b32 v184, v19
    v_mov_b32 v185, v19
    v_mfma_f32_32x32x16_bf16 v[48:63], v[92:95], v[236:239], v[48:63]
    v_mov_b32 v186, v19
    v_mov_b32 v187, v19
    s_waitcnt lgkmcnt(0)
    v_dot2c_f32_bf16 v16, v64, v18
    v_dot2c_f32_bf16 v17, v72, v18
    v_dot2c_f32_bf16 v16, v65, v18
    v_dot2c_f32_bf16 v17, v73, v18
    v_dot2c_f32_bf16 v16, v66, v18
    v_dot2c_f32_bf16 v17, v74, v18
    v_dot2c_f32_bf16 v16, v67, v18
    v_dot2c_f32_bf16 v17, v75, v18
    v_mfma_f32_32x32x16_bf16 v[32:47], v[64:67], v[240:243], v[32:47]
    ds_read_b64_tr_b16 v[80:81], v8 offset:8192
    ds_read_b64_tr_b16 v[82:83], v8 offset:8704
    ds_read_b64_tr_b16 v[88:89], v4 offset:8192
    ds_read_b64_tr_b16 v[90:91], v4 offset:8704
    s_mov_b32 vcc_lo, 0x100000
    s_mov_b32 vcc_hi, 0x100000
    v_mov_b32 v19, 0x3f803f80
    v_cndmask_b32 v19, 0, v19, vcc
    v_mfma_f32_32x32x16_bf16 v[48:63], v[72:75], v[240:243], v[48:63]
    ds_read_b64_tr_b16 v[84:85], v9 offset:8192
    ds_read_b64_tr_b16 v[86:87], v9 offset:8704
    ds_read_b64_tr_b16 v[92:93], v5 offset:8192
    ds_read_b64_tr_b16 v[94:95], v5 offset:8704
    v_mov_b32 v204, 0x3f803f80
    v_mov_b32 v205, 0x3f80
    v_mov_b32 v196, v19
    v_mov_b32 v197, v19
    v_mfma_f32_32x32x16_bf16 v[32:47], v[68:71], v[244:247], v[32:47]
    v_mov_b32 v198, v19
    v_mov_b32 v199, v19
    v_mov_b32 v200, v19
    v_mov_b32 v201, v19
    v_mfma_f32_32x32x16_bf16 v[48:63], v[76:79], v[244:247], v[48:63]
    v_mov_b32 v202, v19
    v_mov_b32 v203, v19
    s_waitcnt lgkmcnt(0)
    v_mfma_f32_32x32x16_bf16 v[32:47], v[80:83], v[248:251], v[32:47]
    s_mov_b32 vcc_lo, 0x100000
    s_mov_b32 vcc_hi, 0x100000
    v_mov_b32 v19, 0x3f803f80
    v_cndmask_b32 v19, 0, v19, vcc
    v_mfma_f32_32x32x16_bf16 v[48:63], v[88:91], v[248:251], v[48:63]
    v_mov_b32 v220, 0x3f803f80
    v_mov_b32 v221, 0x3f80
    v_mov_b32 v212, v19
    v_mov_b32 v213, v19
    v_mfma_f32_32x32x16_bf16 v[32:47], v[84:87], v[252:255], v[32:47]
    v_mov_b32 v214, v19
    v_mov_b32 v215, v19
    v_mov_b32 v216, v19
    v_mov_b32 v217, v19
    v_mfma_f32_32x32x16_bf16 v[48:63], v[92:95], v[252:255], v[48:63]
    v_mov_b32 v218, v19
    v_mov_b32 v219, v19
    s_setprio 3
    s_nop 2
    v_cvt_pk_bf16_f32 v64, v16, v16
    v_lshlrev_b32 v64, 16, v64
    v_sub_f32 v64, v16, v64
    v_cvt_pk_bf16_f32 v65, v16, v64
    ds_write_b32 v21, v65 offset:0
    v_cvt_pk_bf16_f32 v64, v17, v17
    v_lshlrev_b32 v64, 16, v64
    v_sub_f32 v64, v17, v64
    v_cvt_pk_bf16_f32 v66, v17, v64
    ds_write_b32 v21, v66 offset:1024
    v_mov_b32 v254, 156932
    v_mov_b32 v255, 1
    s_add_u32 s64, s64, 4
    s_waitcnt lgkmcnt(0)
    s_mov_b64 exec, 1
    ds_add_rtn_u32 v255, v254, v255
    s_mov_b64 exec, -1
    s_waitcnt lgkmcnt(0)
    v_readfirstlane_b32 s40, v255
    s_add_u32 s40, s40, 1
    s_cmp_ge_u32 s40, s64
    s_cbranch_scc1 L_gs_21
    s_mov_b32 s68, 0x2000000
L_lw_22:
    ds_read_b32 v255, v254
    s_sub_u32 s68, s68, 1
    s_cbranch_scc1 L_lwd_23
    s_waitcnt lgkmcnt(0)
    v_readfirstlane_b32 s40, v255
    s_cmp_ge_u32 s40, s64
    s_cbranch_scc1 L_lwd_23
    s_sleep 0
    s_branch L_lw_22
L_lwd_23:
    s_waitcnt lgkmcnt(0)
L_gs_21:
    ds_read_b128 v[84:87], v22
    ds_read_b128 v[88:91], v22 offset:1024
    v_mov_b32 v80, v13
    v_mov_b32 v81, v13
    v_mov_b32 v82, v13
    v_mov_b32 v83, v13
    s_nop 0
    s_waitcnt lgkmcnt(0)
    v_mfma_f32_32x32x16_bf16 v[32:47], v[84:87], v[80:83], v[32:47]
    v_mfma_f32_32x32x16_bf16 v[48:63], v[88:91], v[80:83], v[48:63]
    s_add_u32 s40, s52, s53
    s_add_u32 s41, s52, s54
    s_add_u32 s42, s41, s53
    s_nop 7
    v_pk_mul_f32 v[32:33], v[32:33], v[0:1] op_sel_hi:[1,0]
    v_pk_mul_f32 v[34:35], v[34:35], v[0:1] op_sel_hi:[1,0]
    v_pk_mul_f32 v[36:37], v[36:37], v[0:1] op_sel_hi:[1,0]
    v_pk_mul_f32 v[38:39], v[38:39], v[0:1] op_sel_hi:[1,0]
    v_pk_mul_f32 v[40:41], v[40:41], v[0:1] op_sel_hi:[1,0]
    v_pk_mul_f32 v[42:43], v[42:43], v[0:1] op_sel_hi:[1,0]
    v_pk_mul_f32 v[44:45], v[44:45], v[0:1] op_sel_hi:[1,0]
    v_pk_mul_f32 v[46:47], v[46:47], v[0:1] op_sel_hi:[1,0]
    v_cvt_pk_bf16_f32 v64, v32, v33
    v_cvt_pk_bf16_f32 v65, v34, v35
    v_cvt_pk_bf16_f32 v66, v36, v37
    v_cvt_pk_bf16_f32 v67, v38, v39
    v_cvt_pk_bf16_f32 v68, v40, v41
    v_cvt_pk_bf16_f32 v69, v42, v43
    v_cvt_pk_bf16_f32 v70, v44, v45
    v_cvt_pk_bf16_f32 v71, v46, v47
    s_cmp_lg_u32 s35, 2
    s_cbranch_scc1 L_notv_25
    v_mfma_f32_32x32x16_bf16 v[32:47], v[64:67], v[24:27], 0
    v_mfma_f32_32x32x16_bf16 v[32:47], v[68:71], v[28:31], v[32:47]
    s_nop 11
    v_cvt_pk_bf16_f32 v64, v32, v33
    v_cvt_pk_bf16_f32 v65, v34, v35
    v_cvt_pk_bf16_f32 v66, v36, v37
    v_cvt_pk_bf16_f32 v67, v38, v39
    v_cvt_pk_bf16_f32 v68, v40, v41
    v_cvt_pk_bf16_f32 v69, v42, v43
    v_cvt_pk_bf16_f32 v70, v44, v45
    v_cvt_pk_bf16_f32 v71, v46, v47
L_notv_25:
    buffer_store_dwordx4 v[64:67], v23, s[12:15], s52 offen sc1
    buffer_store_dwordx4 v[68:71], v23, s[12:15], s40 offen sc1
    v_pk_mul_f32 v[48:49], v[48:49], v[0:1] op_sel_hi:[1,0]
    v_pk_mul_f32 v[50:51], v[50:51], v[0:1] op_sel_hi:[1,0]
    v_pk_mul_f32 v[52:53], v[52:53], v[0:1] op_sel_hi:[1,0]
    v_pk_mul_f32 v[54:55], v[54:55], v[0:1] op_sel_hi:[1,0]
    v_pk_mul_f32 v[56:57], v[56:57], v[0:1] op_sel_hi:[1,0]
    v_pk_mul_f32 v[58:59], v[58:59], v[0:1] op_sel_hi:[1,0]
    v_pk_mul_f32 v[60:61], v[60:61], v[0:1] op_sel_hi:[1,0]
    v_pk_mul_f32 v[62:63], v[62:63], v[0:1] op_sel_hi:[1,0]
    v_cvt_pk_bf16_f32 v72, v48, v49
    v_cvt_pk_bf16_f32 v73, v50, v51
    v_cvt_pk_bf16_f32 v74, v52, v53
    v_cvt_pk_bf16_f32 v75, v54, v55
    v_cvt_pk_bf16_f32 v76, v56, v57
    v_cvt_pk_bf16_f32 v77, v58, v59
    v_cvt_pk_bf16_f32 v78, v60, v61
    v_cvt_pk_bf16_f32 v79, v62, v63
    s_cmp_lg_u32 s35, 2
    s_cbranch_scc1 L_notv_26
    v_mfma_f32_32x32x16_bf16 v[48:63], v[72:75], v[24:27], 0
    v_mfma_f32_32x32x16_bf16 v[48:63], v[76:79], v[28:31], v[48:63]
    s_nop 11
    v_cvt_pk_bf16_f32 v72, v48, v49
    v_cvt_pk_bf16_f32 v73, v50, v51
    v_cvt_pk_bf16_f32 v74, v52, v53
    v_cvt_pk_bf16_f32 v75, v54, v55
    v_cvt_pk_bf16_f32 v76, v56, v57
    v_cvt_pk_bf16_f32 v77, v58, v59
    v_cvt_pk_bf16_f32 v78, v60, v61
    v_cvt_pk_bf16_f32 v79, v62, v63
L_notv_26:
    buffer_store_dwordx4 v[72:75], v23, s[12:15], s41 offen sc1
    buffer_store_dwordx4 v[76:79], v23, s[12:15], s42 offen sc1
    s_lshr_b32 s42, s32, 1
    s_mul_i32 s42, s42, 5
    s_mul_i32 s43, s26, 40
    s_add_u32 s42, s42, s43
    s_and_b32 s43, s32, 1
    s_mul_i32 s69, s43, 3
    s_add_u32 s69, s69, s42
    s_lshl_b32 s69, s69, 9
    v_lshlrev_b32 v2, 4, v1
    v_add_u32 v2, s69, v2
    s_add_u32 s42, s42, 2
    s_lshl_b32 s42, s42, 9
    s_lshl_b32 s43, s43, 3
    s_add_u32 s42, s42, s43
    v_and_b32 v10, 31, v1
    v_lshlrev_b32 v4, 4, v10
    v_add_u32 v3, s42, v4
    s_mul_i32 s42, s32, 320
    s_mul_i32 s43, s26, 5120
    s_add_u32 s42, s42, s43
    s_add_u32 s42, s42, 2621440
    v_lshrrev_b32 v11, 5, v1
    v_mul_u32_u24 v5, 10240, v11
    v_add3_u32 v4, v4, v5, s42
    v_add_u32 v5, 20480, v4
    s_lshl_b32 s42, s26, 2
    s_add_u32 s42, s42, 156928
    v_mov_b32 v12, s42
    v_mov_b32 v13, 0xdddd
    s_mul_i32 s56, s25, 40960
    s_add_u32 s56, s56, 3670016
    s_add_u32 s57, s56, 2621440
    s_mul_i32 s66, s31, 163840
    s_add_u32 s66, s66, s56
    s_add_u32 s42, s25, 1
    s_and_b32 s42, s42, 3
    s_lshl_b32 s43, s31, 2
    s_add_u32 s42, s42, s43
    s_mul_i32 s42, s42, 40960
    s_add_u32 s44, s42, 1048576
    s_add_u32 s42, s25, 2
    s_and_b32 s42, s42, 3
    s_lshl_b32 s43, s31, 2
    s_add_u32 s42, s42, s43
    s_mul_i32 s42, s42, 40960
    s_add_u32 s45, s42, 1048576
    s_add_u32 s42, s25, 3
    s_and_b32 s42, s42, 3
    s_lshl_b32 s43, s31, 2
    s_add_u32 s42, s42, s43
    s_mul_i32 s42, s42, 40960
    s_add_u32 s46, s42, 1048576
    s_add_u32 s42, s25, 4
    s_and_b32 s42, s42, 3
    s_lshl_b32 s43, s31, 2
    s_add_u32 s42, s42, s43
    s_mul_i32 s42, s42, 40960
    s_add_u32 s47, s42, 1048576
    s_mul_i32 s42, s32, 20
    s_add_u32 s43, s42, 19
    s_lshr_b32 s42, s42, 6
    s_lshr_b32 s43, s43, 6
    s_sub_u32 s43, s43, s42
    v_and_b32 v15, 1, v1
    v_mul_u32_u24 v15, s43, v15
    v_add_u32 v15, s42, v15
    v_bfe_u32 v14, v1, 1, 1
    v_mul_u32_u24 v14, 5, v14
    v_add3_u32 v14, v14, v15, 5
    v_lshrrev_b32 v19, 2, v1
    v_lshl_add_u32 v14, v19, 4, v14
    v_lshlrev_b32 v14, 7, v14
    v_lshlrev_b32 v15, 7, v15
    v_mov_b32 v248, v14
    s_lshl_b32 s48, s26, 15
    s_add_u32 s48, s48, 655360
    s_lshl_b32 s49, s31, 11
    s_add_u32 s49, s49, s48
    s_waitcnt vmcnt(0)
    v_mov_b32 v255, 1
    s_add_u32 s64, s64, 4
    s_waitcnt lgkmcnt(0)
    s_mov_b64 exec, 1
    ds_add_rtn_u32 v255, v12, v255
    s_mov_b64 exec, -1
    s_waitcnt lgkmcnt(0)
    v_readfirstlane_b32 s40, v255
    s_add_u32 s40, s40, 1
    s_cmp_ge_u32 s40, s64
    s_cbranch_scc1 L_gs_27
    s_mov_b32 s68, 0x2000000
L_lw_28:
    ds_read_b32 v255, v12
    s_sub_u32 s68, s68, 1
    s_cbranch_scc1 L_lwd_29
    s_waitcnt lgkmcnt(0)
    v_readfirstlane_b32 s40, v255
    s_cmp_ge_u32 s40, s64
    s_cbranch_scc1 L_lwd_29
    s_sleep 0
    s_branch L_lw_28
L_lwd_29:
    s_waitcnt lgkmcnt(0)
L_gs_27:
    s_cmp_lg_u32 s25, 0
    s_cbranch_scc1 L_f1_30
    s_lshl_b32 s40, s28, 11
    s_lshl_b32 s41, s29, 7
    s_add_u32 s40, s40, s41
    s_lshl_b32 s41, s26, 15
    s_add_u32 s40, s40, s41
    s_add_u32 s40, s40, 655360
    v_mov_b32 v255, s27
    v_mov_b32 v254, 0
    s_mov_b64 exec, 1
    buffer_store_dword v255, v254, s[12:15], s40 offen sc1
    s_mov_b64 exec, -1
L_f1_30:
    s_branch L_m1
L_spare:
    s_waitcnt lgkmcnt(0)
    s_barrier
    s_cmp_eq_u32 s26, 1
    s_cbranch_scc1 L_spb
    s_waitcnt vmcnt(0)
    v_mov_b32 v56, 0
    v_mov_b32 v57, 0
    v_mov_b32 v58, 0
    v_mov_b32 v59, 0
    v_dot2c_f32_bf16 v56, v40, v40
    v_dot2c_f32_bf16 v57, v40, v18
    v_dot2c_f32_bf16 v58, v40, v64
    v_dot2c_f32_bf16 v59, v64, v18
    v_dot2c_f32_bf16 v56, v41, v41
    v_dot2c_f32_bf16 v57, v41, v18
    v_dot2c_f32_bf16 v58, v41, v65
    v_dot2c_f32_bf16 v59, v65, v18
    v_dot2c_f32_bf16 v56, v42, v42
    v_dot2c_f32_bf16 v57, v42, v18
    v_dot2c_f32_bf16 v58, v42, v66
    v_dot2c_f32_bf16 v59, v66, v18
    v_dot2c_f32_bf16 v56, v43, v43
    v_dot2c_f32_bf16 v57, v43, v18
    v_dot2c_f32_bf16 v58, v43, v67
    v_dot2c_f32_bf16 v59, v67, v18
    v_dot2c_f32_bf16 v56, v44, v44
    v_dot2c_f32_bf16 v57, v44, v18
    v_dot2c_f32_bf16 v58, v44, v68
    v_dot2c_f32_bf16 v59, v68, v18
    v_dot2c_f32_bf16 v56, v45, v45
    v_dot2c_f32_bf16 v57, v45, v18
    v_dot2c_f32_bf16 v58, v45, v69
    v_dot2c_f32_bf16 v59, v69, v18
    v_dot2c_f32_bf16 v56, v46, v46
    v_dot2c_f32_bf16 v57, v46, v18
    v_dot2c_f32_bf16 v58, v46, v70
    v_dot2c_f32_bf16 v59, v70, v18
    v_dot2c_f32_bf16 v56, v47, v47
    v_dot2c_f32_bf16 v57, v47, v18
    v_dot2c_f32_bf16 v58, v47, v71
    v_dot2c_f32_bf16 v59, v71, v18
    v_dot2c_f32_bf16 v56, v48, v48
    v_dot2c_f32_bf16 v57, v48, v18
    v_dot2c_f32_bf16 v58, v48, v72
    v_dot2c_f32_bf16 v59, v72, v18
    v_dot2c_f32_bf16 v56, v49, v49
    v_dot2c_f32_bf16 v57, v49, v18
    v_dot2c_f32_bf16 v58, v49, v73
    v_dot2c_f32_bf16 v59, v73, v18
    v_dot2c_f32_bf16 v56, v50, v50
    v_dot2c_f32_bf16 v57, v50, v18
    v_dot2c_f32_bf16 v58, v50, v74
    v_dot2c_f32_bf16 v59, v74, v18
    v_dot2c_f32_bf16 v56, v51, v51
    v_dot2c_f32_bf16 v57, v51, v18
    v_dot2c_f32_bf16 v58, v51, v75
    v_dot2c_f32_bf16 v59, v75, v18
    s_nop 2
    v_add_f32_dpp v56, v56, v56 row_ror:1 row_mask:0xf bank_mask:0xf
    v_add_f32_dpp v57, v57, v57 row_ror:1 row_mask:0xf bank_mask:0xf
    v_add_f32_dpp v58, v58, v58 row_ror:1 row_mask:0xf bank_mask:0xf
    v_add_f32_dpp v59, v59, v59 row_ror:1 row_mask:0xf bank_mask:0xf
    v_add_f32_dpp v56, v56, v56 row_ror:2 row_mask:0xf bank_mask:0xf
    v_add_f32_dpp v57, v57, v57 row_ror:2 row_mask:0xf bank_mask:0xf
    v_add_f32_dpp v58, v58, v58 row_ror:2 row_mask:0xf bank_mask:0xf
    v_add_f32_dpp v59, v59, v59 row_ror:2 row_mask:0xf bank_mask:0xf
    v_add_f32_dpp v56, v56, v56 row_ror:4 row_mask:0xf bank_mask:0xf
    v_add_f32_dpp v57, v57, v57 row_ror:4 row_mask:0xf bank_mask:0xf
    v_add_f32_dpp v58, v58, v58 row_ror:4 row_mask:0xf bank_mask:0xf
    v_add_f32_dpp v59, v59, v59 row_ror:4 row_mask:0xf bank_mask:0xf
    v_add_f32_dpp v56, v56, v56 row_ror:8 row_mask:0xf bank_mask:0xf
    v_add_f32_dpp v57, v57, v57 row_ror:8 row_mask:0xf bank_mask:0xf
    v_add_f32_dpp v58, v58, v58 row_ror:8 row_mask:0xf bank_mask:0xf
    v_add_f32_dpp v59, v59, v59 row_ror:8 row_mask:0xf bank_mask:0xf
    v_add_f32_dpp v56, v56, v56 row_bcast:15 row_mask:0xa bank_mask:0xf
    v_add_f32_dpp v57, v57, v57 row_bcast:15 row_mask:0xa bank_mask:0xf
    v_add_f32_dpp v58, v58, v58 row_bcast:15 row_mask:0xa bank_mask:0xf
    v_add_f32_dpp v59, v59, v59 row_bcast:15 row_mask:0xa bank_mask:0xf
    v_mul_f32 v57, 0x3acccccd, v57
    v_mul_f32 v56, 0x3acccccd, v56
    v_fma_f32 v56, -v57, v57, v56
    v_max_f32 v56, 0, v56
    v_cvt_pk_bf16_f32 v57, v57, v57
    v_lshlrev_b32 v57, 16, v57
    v_cvt_pk_bf16_f32 v56, v56, v56
    v_lshlrev_b32 v56, 16, v56
    v_add_f32 v56, 0x3727c5ac, v56
    v_cvt_pk_bf16_f32 v56, v56, v56
    v_lshlrev_b32 v56, 16, v56
    v_sqrt_f32 v56, v56
    v_fma_f32 v58, -v57, v59, v58
    v_cvt_pk_bf16_f32 v56, v56, v56
    v_lshlrev_b32 v56, 16, v56
    v_rcp_f32 v59, v56
    v_lshrrev_b32 v57, 16, v57
    v_or_b32 v60, v57, v56
    v_mul_f32 v58, v58, v59
    v_cvt_pk_bf16_f32 v58, v58, v58
    v_lshlrev_b32 v58, 16, v58
    s_lshl_b32 s40, s25, 1
    s_add_u32 s40, s40, s55
    v_add_u32 v57, s40, v34
    v_ashrrev_i32 v59, 31, v58
    v_or_b32 v59, 0x80000000, v59
    v_xor_b32 v58, v58, v59
    v_and_b32 v58, 0xffff0000, v58
    v_sub_u32 v59, 2047, v57
    v_or_b32 v62, v59, v58
    s_add_u32 s27, s27, 0x9e3779b1
    v_mov_b32 v59, 156960
    v_mov_b32 v61, s27
    v_mov_b32 v63, s27
    v_lshlrev_b32 v57, 3, v57
    s_mov_b32 s40, 65536
    s_mov_b32 s41, 81920
    s_brev_b32 exec_lo, 1
    s_brev_b32 exec_hi, 1
    buffer_store_dwordx2 v[60:61], v57, s[12:15], s40 offen sc1
    buffer_store_dwordx2 v[62:63], v57, s[12:15], s41 offen sc1
    s_mov_b64 exec, -1
    s_cmp_lg_u32 s24, 0
    s_cbranch_scc1 L_epd_31
    ds_write_b32 v59, v61
L_epd_31:
L_spb:
    s_waitcnt lgkmcnt(0)
    s_barrier
    v_mov_b32 v19, 156960
    ds_read_b32 v19, v19
    s_waitcnt lgkmcnt(0)
    v_readfirstlane_b32 s27, v19
    s_lshl_b32 s40, s28, 3
    s_add_u32 s40, s40, s24
    s_cmp_lg_u32 s40, 0
    s_cbranch_scc0 L_sel0
    s_branch L_seld
L_sel0:
    v_lshlrev_b32 v96, 4, v1
    v_and_b32 v116, 31, v1
    v_lshrrev_b32 v117, 5, v1
    s_mov_b32 s68, 0x100000
L_keys:
    s_sleep 8
    s_mov_b32 s40, 81920
    buffer_load_dwordx4 v[32:35], v96, s[12:15], s40 offen offset:0 sc1
    buffer_load_dwordx4 v[36:39], v96, s[12:15], s40 offen offset:1024 sc1
    buffer_load_dwordx4 v[40:43], v96, s[12:15], s40 offen offset:2048 sc1
    buffer_load_dwordx4 v[44:47], v96, s[12:15], s40 offen offset:3072 sc1
    s_add_u32 s40, s40, 4096
    buffer_load_dwordx4 v[48:51], v96, s[12:15], s40 offen offset:0 sc1
    buffer_load_dwordx4 v[52:55], v96, s[12:15], s40 offen offset:1024 sc1
    buffer_load_dwordx4 v[56:59], v96, s[12:15], s40 offen offset:2048 sc1
    buffer_load_dwordx4 v[60:63], v96, s[12:15], s40 offen offset:3072 sc1
    s_add_u32 s40, s40, 4096
    buffer_load_dwordx4 v[64:67], v96, s[12:15], s40 offen offset:0 sc1
    buffer_load_dwordx4 v[68:71], v96, s[12:15], s40 offen offset:1024 sc1
    buffer_load_dwordx4 v[72:75], v96, s[12:15], s40 offen offset:2048 sc1
    buffer_load_dwordx4 v[76:79], v96, s[12:15], s40 offen offset:3072 sc1
    s_add_u32 s40, s40, 4096
    buffer_load_dwordx4 v[80:83], v96, s[12:15], s40 offen offset:0 sc1
    buffer_load_dwordx4 v[84:87], v96, s[12:15], s40 offen offset:1024 sc1
    buffer_load_dwordx4 v[88:91], v96, s[12:15], s40 offen offset:2048 sc1
    buffer_load_dwordx4 v[92:95], v96, s[12:15], s40 offen offset:3072 sc1
    s_sub_u32 s68, s68, 1
    s_waitcnt vmcnt(0)
    s_cbranch_scc1 L_keysok
    v_xor_b32 v97, s27, v33
    v_xor_b32 v98, s27, v35
    v_or_b32 v97, v97, v98
    v_xor_b32 v98, s27, v37
    v_or_b32 v97, v97, v98
    v_xor_b32 v98, s27, v39
    v_or_b32 v97, v97, v98
    v_xor_b32 v98, s27, v41
    v_or_b32 v97, v97, v98
    v_xor_b32 v98, s27, v43
    v_or_b32 v97, v97, v98
    v_xor_b32 v98, s27, v45
    v_or_b32 v97, v97, v98
    v_xor_b32 v98, s27, v47
    v_or_b32 v97, v97, v98
    v_xor_b32 v98, s27, v49
    v_or_b32 v97, v97, v98
    v_xor_b32 v98, s27, v51
    v_or_b32 v97, v97, v98
    v_xor_b32 v98, s27, v53
    v_or_b32 v97, v97, v98
    v_xor_b32 v98, s27, v55
    v_or_b32 v97, v97, v98
    v_xor_b32 v98, s27, v57
    v_or_b32 v97, v97, v98
    v_xor_b32 v98, s27, v59
    v_or_b32 v97, v97, v98
    v_xor_b32 v98, s27, v61
    v_or_b32 v97, v97, v98
    v_xor_b32 v98, s27, v63
    v_or_b32 v97, v97, v98
    v_xor_b32 v98, s27, v65
    v_or_b32 v97, v97, v98
    v_xor_b32 v98, s27, v67
    v_or_b32 v97, v97, v98
    v_xor_b32 v98, s27, v69
    v_or_b32 v97, v97, v98
    v_xor_b32 v98, s27, v71
    v_or_b32 v97, v97, v98
    v_xor_b32 v98, s27, v73
    v_or_b32 v97, v97, v98
    v_xor_b32 v98, s27, v75
    v_or_b32 v97, v97, v98
    v_xor_b32 v98, s27, v77
    v_or_b32 v97, v97, v98
    v_xor_b32 v98, s27, v79
    v_or_b32 v97, v97, v98
    v_xor_b32 v98, s27, v81
    v_or_b32 v97, v97, v98
    v_xor_b32 v98, s27, v83
    v_or_b32 v97, v97, v98
    v_xor_b32 v98, s27, v85
    v_or_b32 v97, v97, v98
    v_xor_b32 v98, s27, v87
    v_or_b32 v97, v97, v98
    v_xor_b32 v98, s27, v89
    v_or_b32 v97, v97, v98
    v_xor_b32 v98, s27, v91
    v_or_b32 v97, v97, v98
    v_xor_b32 v98, s27, v93
    v_or_b32 v97, v97, v98
    v_xor_b32 v98, s27, v95
    v_or_b32 v97, v97, v98
    v_cmp_ne_u32 vcc, 0, v97
    s_cbranch_vccnz L_keys
L_keysok:
    s_mov_b32 s40, 0
    v_mov_b32 v255, s27
    v_mov_b32 v254, 0
    s_mov_b64 exec, 1
    buffer_store_dword v255, v254, s[12:15], s40 offen sc1
    s_mov_b64 exec, -1
    v_max_u32 v97, v32, v34
    v_min_u32 v98, v32, v34
    v_med3_u32 v98, v97, v98, v36
    v_max_u32 v97, v97, v36
    v_med3_u32 v98, v97, v98, v38
    v_max_u32 v97, v97, v38
    v_med3_u32 v98, v97, v98, v40
    v_max_u32 v97, v97, v40
    v_med3_u32 v98, v97, v98, v42
    v_max_u32 v97, v97, v42
    v_med3_u32 v98, v97, v98, v44
    v_max_u32 v97, v97, v44
    v_med3_u32 v98, v97, v98, v46
    v_max_u32 v97, v97, v46
    v_med3_u32 v98, v97, v98, v48
    v_max_u32 v97, v97, v48
    v_med3_u32 v98, v97, v98, v50
    v_max_u32 v97, v97, v50
    v_med3_u32 v98, v97, v98, v52
    v_max_u32 v97, v97, v52
    v_med3_u32 v98, v97, v98, v54
    v_max_u32 v97, v97, v54
    v_med3_u32 v98, v97, v98, v56
    v_max_u32 v97, v97, v56
    v_med3_u32 v98, v97, v98, v58
    v_max_u32 v97, v97, v58
    v_med3_u32 v98, v97, v98, v60
    v_max_u32 v97, v97, v60
    v_med3_u32 v98, v97, v98, v62
    v_max_u32 v97, v97, v62
    v_med3_u32 v98, v97, v98, v64
    v_max_u32 v97, v97, v64
    v_med3_u32 v98, v97, v98, v66
    v_max_u32 v97, v97, v66
    v_med3_u32 v98, v97, v98, v68
    v_max_u32 v97, v97, v68
    v_med3_u32 v98, v97, v98, v70
    v_max_u32 v97, v97, v70
    v_med3_u32 v98, v97, v98, v72
    v_max_u32 v97, v97, v72
    v_med3_u32 v98, v97, v98, v74
    v_max_u32 v97, v97, v74
    v_med3_u32 v98, v97, v98, v76
    v_max_u32 v97, v97, v76
    v_med3_u32 v98, v97, v98, v78
    v_max_u32 v97, v97, v78
    v_med3_u32 v98, v97, v98, v80
    v_max_u32 v97, v97, v80
    v_med3_u32 v98, v97, v98, v82
    v_max_u32 v97, v97, v82
    v_med3_u32 v98, v97, v98, v84
    v_max_u32 v97, v97, v84
    v_med3_u32 v98, v97, v98, v86
    v_max_u32 v97, v97, v86
    v_med3_u32 v98, v97, v98, v88
    v_max_u32 v97, v97, v88
    v_med3_u32 v98, v97, v98, v90
    v_max_u32 v97, v97, v90
    v_med3_u32 v98, v97, v98, v92
    v_max_u32 v97, v97, v92
    v_med3_u32 v98, v97, v98, v94
    v_max_u32 v97, v97, v94
    v_mov_b32 v99, v97
    s_nop 1
    v_max_u32_dpp v99, v99, v99 row_ror:1 row_mask:0xf bank_mask:0xf
    s_nop 1
    v_max_u32_dpp v99, v99, v99 row_ror:2 row_mask:0xf bank_mask:0xf
    s_nop 1
    v_max_u32_dpp v99, v99, v99 row_ror:4 row_mask:0xf bank_mask:0xf
    s_nop 1
    v_max_u32_dpp v99, v99, v99 row_ror:8 row_mask:0xf bank_mask:0xf
    s_nop 1
    v_max_u32_dpp v99, v99, v99 row_bcast:15 row_mask:0xa bank_mask:0xf
    s_nop 1
    v_max_u32_dpp v99, v99, v99 row_bcast:31 row_mask:0xc bank_mask:0xf
    s_nop 0
    v_readlane_b32 s52, v99, 63
    s_nop 1
    v_cmp_eq_u32 vcc, s52, v97
    s_nop 1
    v_cndmask_b32 v99, v97, v98, vcc
    s_nop 1
    v_max_u32_dpp v99, v99, v99 row_ror:1 row_mask:0xf bank_mask:0xf
    s_nop 1
    v_max_u32_dpp v99, v99, v99 row_ror:2 row_mask:0xf bank_mask:0xf
    s_nop 1
    v_max_u32_dpp v99, v99, v99 row_ror:4 row_mask:0xf bank_mask:0xf
    s_nop 1
    v_max_u32_dpp v99, v99, v99 row_ror:8 row_mask:0xf bank_mask:0xf
    s_nop 1
    v_max_u32_dpp v99, v99, v99 row_bcast:15 row_mask:0xa bank_mask:0xf
    s_nop 1
    v_max_u32_dpp v99, v99, v99 row_bcast:31 row_mask:0xc bank_mask:0xf
    s_nop 0
    v_readlane_b32 s53, v99, 63
    s_nop 1
    v_mov_b32 v97, s53
    s_mov_b64 exec, s[60:61]
    v_mov_b32 v97, s52
    s_mov_b64 exec, -1
    v_and_b32 v98, 0x7ff, v97
    v_sub_u32 v98, 2047, v98
    v_mul_u32_u24 v105, 1280, v98
    v_lshl_add_u32 v105, v116, 2, v105
    buffer_load_dword v32, v105, s[4:7], 0 offen offset:0
    buffer_load_dword v33, v105, s[4:7], 0 offen offset:128
    buffer_load_dword v34, v105, s[4:7], 0 offen offset:256
    buffer_load_dword v35, v105, s[4:7], 0 offen offset:384
    buffer_load_dword v36, v105, s[4:7], 0 offen offset:512
    buffer_load_dword v37, v105, s[4:7], 0 offen offset:640
    buffer_load_dword v38, v105, s[4:7], 0 offen offset:768
    buffer_load_dword v39, v105, s[4:7], 0 offen offset:896
    buffer_load_dword v40, v105, s[4:7], 0 offen offset:1024
    buffer_load_dword v41, v105, s[4:7], 0 offen offset:1152
    v_lshlrev_b32 v105, 3, v98
    s_mov_b32 s40, 65536
    s_mov_b32 s68, 0x100000
L_tg_32:
    buffer_load_dwordx2 v[106:107], v105, s[12:15], s40 offen sc1
    s_sub_u32 s68, s68, 1
    s_waitcnt vmcnt(0)
    s_cbranch_scc1 L_tgd_33
L_tgc_34:
    v_cmp_ne_u32 vcc, s27, v107
    s_cbranch_vccnz L_tg_32
L_tgd_33:
    v_ashrrev_i32 v99, 31, v97
    v_not_b32 v99, v99
    v_or_b32 v99, 0x80000000, v99
    v_xor_b32 v99, v99, v97
    v_and_b32 v99, 0xffff0000, v99
    v_mul_f32 v99, 0xbfb8aa3b, v99
    v_exp_f32 v99, v99
    v_lshlrev_b32 v100, 3, v117
    v_add_f32 v99, 1.0, v99
    v_rcp_f32 v99, v99
    v_mul_u32_u24 v105, 1280, v117
    v_cvt_pk_bf16_f32 v99, v99, v99
    v_lshlrev_b32 v99, 16, v99
    v_lshl_add_u32 v105, v116, 2, v105
    s_mov_b32 s40, 102400
    s_mov_b32 s41, 98304
    buffer_store_dwordx2 v[98:99], v100, s[12:15], s40 offen sc1
    v_lshlrev_b32 v108, 16, v106
    v_and_b32 v109, 0xffff0000, v106
    v_rcp_f32 v110, v109
    v_lshlrev_b32 v111, 16, v32
    v_and_b32 v112, 0xffff0000, v32
    v_sub_f32 v111, v111, v108
    v_sub_f32 v112, v112, v108
    v_cvt_pk_bf16_f32 v108, v111, v112
    v_lshlrev_b32 v111, 16, v108
    v_and_b32 v112, 0xffff0000, v108
    v_mul_f32 v108, v111, v110
    v_fma_f32 v111, -v108, v109, v111
    v_fma_f32 v111, v111, v110, v108
    v_mul_f32 v108, v112, v110
    v_fma_f32 v112, -v108, v109, v112
    v_fma_f32 v112, v112, v110, v108
    v_cvt_pk_bf16_f32 v48, v111, v112
    buffer_store_dword v48, v105, s[12:15], s41 offen offset:0 sc1
    v_lshlrev_b32 v108, 16, v106
    v_and_b32 v109, 0xffff0000, v106
    v_rcp_f32 v110, v109
    v_lshlrev_b32 v111, 16, v33
    v_and_b32 v112, 0xffff0000, v33
    v_sub_f32 v111, v111, v108
    v_sub_f32 v112, v112, v108
    v_cvt_pk_bf16_f32 v108, v111, v112
    v_lshlrev_b32 v111, 16, v108
    v_and_b32 v112, 0xffff0000, v108
    v_mul_f32 v108, v111, v110
    v_fma_f32 v111, -v108, v109, v111
    v_fma_f32 v111, v111, v110, v108
    v_mul_f32 v108, v112, v110
    v_fma_f32 v112, -v108, v109, v112
    v_fma_f32 v112, v112, v110, v108
    v_cvt_pk_bf16_f32 v49, v111, v112
    buffer_store_dword v49, v105, s[12:15], s41 offen offset:128 sc1
    v_lshlrev_b32 v108, 16, v106
    v_and_b32 v109, 0xffff0000, v106
    v_rcp_f32 v110, v109
    v_lshlrev_b32 v111, 16, v34
    v_and_b32 v112, 0xffff0000, v34
    v_sub_f32 v111, v111, v108
    v_sub_f32 v112, v112, v108
    v_cvt_pk_bf16_f32 v108, v111, v112
    v_lshlrev_b32 v111, 16, v108
    v_and_b32 v112, 0xffff0000, v108
    v_mul_f32 v108, v111, v110
    v_fma_f32 v111, -v108, v109, v111
    v_fma_f32 v111, v111, v110, v108
    v_mul_f32 v108, v112, v110
    v_fma_f32 v112, -v108, v109, v112
    v_fma_f32 v112, v112, v110, v108
    v_cvt_pk_bf16_f32 v50, v111, v112
    buffer_store_dword v50, v105, s[12:15], s41 offen offset:256 sc1
    v_lshlrev_b32 v108, 16, v106
    v_and_b32 v109, 0xffff0000, v106
    v_rcp_f32 v110, v109
    v_lshlrev_b32 v111, 16, v35
    v_and_b32 v112, 0xffff0000, v35
    v_sub_f32 v111, v111, v108
    v_sub_f32 v112, v112, v108
    v_cvt_pk_bf16_f32 v108, v111, v112
    v_lshlrev_b32 v111, 16, v108
    v_and_b32 v112, 0xffff0000, v108
    v_mul_f32 v108, v111, v110
    v_fma_f32 v111, -v108, v109, v111
    v_fma_f32 v111, v111, v110, v108
    v_mul_f32 v108, v112, v110
    v_fma_f32 v112, -v108, v109, v112
    v_fma_f32 v112, v112, v110, v108
    v_cvt_pk_bf16_f32 v51, v111, v112
    buffer_store_dword v51, v105, s[12:15], s41 offen offset:384 sc1
    v_lshlrev_b32 v108, 16, v106
    v_and_b32 v109, 0xffff0000, v106
    v_rcp_f32 v110, v109
    v_lshlrev_b32 v111, 16, v36
    v_and_b32 v112, 0xffff0000, v36
    v_sub_f32 v111, v111, v108
    v_sub_f32 v112, v112, v108
    v_cvt_pk_bf16_f32 v108, v111, v112
    v_lshlrev_b32 v111, 16, v108
    v_and_b32 v112, 0xffff0000, v108
    v_mul_f32 v108, v111, v110
    v_fma_f32 v111, -v108, v109, v111
    v_fma_f32 v111, v111, v110, v108
    v_mul_f32 v108, v112, v110
    v_fma_f32 v112, -v108, v109, v112
    v_fma_f32 v112, v112, v110, v108
    v_cvt_pk_bf16_f32 v52, v111, v112
    buffer_store_dword v52, v105, s[12:15], s41 offen offset:512 sc1
    v_lshlrev_b32 v108, 16, v106
    v_and_b32 v109, 0xffff0000, v106
    v_rcp_f32 v110, v109
    v_lshlrev_b32 v111, 16, v37
    v_and_b32 v112, 0xffff0000, v37
    v_sub_f32 v111, v111, v108
    v_sub_f32 v112, v112, v108
    v_cvt_pk_bf16_f32 v108, v111, v112
    v_lshlrev_b32 v111, 16, v108
    v_and_b32 v112, 0xffff0000, v108
    v_mul_f32 v108, v111, v110
    v_fma_f32 v111, -v108, v109, v111
    v_fma_f32 v111, v111, v110, v108
    v_mul_f32 v108, v112, v110
    v_fma_f32 v112, -v108, v109, v112
    v_fma_f32 v112, v112, v110, v108
    v_cvt_pk_bf16_f32 v53, v111, v112
    buffer_store_dword v53, v105, s[12:15], s41 offen offset:640 sc1
    v_lshlrev_b32 v108, 16, v106
    v_and_b32 v109, 0xffff0000, v106
    v_rcp_f32 v110, v109
    v_lshlrev_b32 v111, 16, v38
    v_and_b32 v112, 0xffff0000, v38
    v_sub_f32 v111, v111, v108
    v_sub_f32 v112, v112, v108
    v_cvt_pk_bf16_f32 v108, v111, v112
    v_lshlrev_b32 v111, 16, v108
    v_and_b32 v112, 0xffff0000, v108
    v_mul_f32 v108, v111, v110
    v_fma_f32 v111, -v108, v109, v111
    v_fma_f32 v111, v111, v110, v108
    v_mul_f32 v108, v112, v110
    v_fma_f32 v112, -v108, v109, v112
    v_fma_f32 v112, v112, v110, v108
    v_cvt_pk_bf16_f32 v54, v111, v112
    buffer_store_dword v54, v105, s[12:15], s41 offen offset:768 sc1
    v_lshlrev_b32 v108, 16, v106
    v_and_b32 v109, 0xffff0000, v106
    v_rcp_f32 v110, v109
    v_lshlrev_b32 v111, 16, v39
    v_and_b32 v112, 0xffff0000, v39
    v_sub_f32 v111, v111, v108
    v_sub_f32 v112, v112, v108
    v_cvt_pk_bf16_f32 v108, v111, v112
    v_lshlrev_b32 v111, 16, v108
    v_and_b32 v112, 0xffff0000, v108
    v_mul_f32 v108, v111, v110
    v_fma_f32 v111, -v108, v109, v111
    v_fma_f32 v111, v111, v110, v108
    v_mul_f32 v108, v112, v110
    v_fma_f32 v112, -v108, v109, v112
    v_fma_f32 v112, v112, v110, v108
    v_cvt_pk_bf16_f32 v55, v111, v112
    buffer_store_dword v55, v105, s[12:15], s41 offen offset:896 sc1
    v_lshlrev_b32 v108, 16, v106
    v_and_b32 v109, 0xffff0000, v106
    v_rcp_f32 v110, v109
    v_lshlrev_b32 v111, 16, v40
    v_and_b32 v112, 0xffff0000, v40
    v_sub_f32 v111, v111, v108
    v_sub_f32 v112, v112, v108
    v_cvt_pk_bf16_f32 v108, v111, v112
    v_lshlrev_b32 v111, 16, v108
    v_and_b32 v112, 0xffff0000, v108
    v_mul_f32 v108, v111, v110
    v_fma_f32 v111, -v108, v109, v111
    v_fma_f32 v111, v111, v110, v108
    v_mul_f32 v108, v112, v110
    v_fma_f32 v112, -v108, v109, v112
    v_fma_f32 v112, v112, v110, v108
    v_cvt_pk_bf16_f32 v56, v111, v112
    buffer_store_dword v56, v105, s[12:15], s41 offen offset:1024 sc1
    v_lshlrev_b32 v108, 16, v106
    v_and_b32 v109, 0xffff0000, v106
    v_rcp_f32 v110, v109
    v_lshlrev_b32 v111, 16, v41
    v_and_b32 v112, 0xffff0000, v41
    v_sub_f32 v111, v111, v108
    v_sub_f32 v112, v112, v108
    v_cvt_pk_bf16_f32 v108, v111, v112
    v_lshlrev_b32 v111, 16, v108
    v_and_b32 v112, 0xffff0000, v108
    v_mul_f32 v108, v111, v110
    v_fma_f32 v111, -v108, v109, v111
    v_fma_f32 v111, v111, v110, v108
    v_mul_f32 v108, v112, v110
    v_fma_f32 v112, -v108, v109, v112
    v_fma_f32 v112, v112, v110, v108
    v_cvt_pk_bf16_f32 v57, v111, v112
    buffer_store_dword v57, v105, s[12:15], s41 offen offset:1152 sc1
    s_mov_b32 s40, 4096
    s_waitcnt vmcnt(0)
    v_mov_b32 v255, s27
    v_mov_b32 v254, 0
    s_mov_b64 exec, 1
    buffer_store_dword v255, v254, s[12:15], s40 offen sc1
    s_mov_b64 exec, -1
L_seld:
    s_setprio 3
    s_lshr_b32 s42, s32, 1
    s_mul_i32 s42, s42, 5
    s_mul_i32 s43, s26, 40
    s_add_u32 s42, s42, s43
    s_and_b32 s43, s32, 1
    s_mul_i32 s69, s43, 3
    s_add_u32 s69, s69, s42
    s_lshl_b32 s69, s69, 9
    v_lshlrev_b32 v2, 4, v1
    v_add_u32 v2, s69, v2
    s_add_u32 s42, s42, 2
    s_lshl_b32 s42, s42, 9
    s_lshl_b32 s43, s43, 3
    s_add_u32 s42, s42, s43
    v_and_b32 v10, 31, v1
    v_lshlrev_b32 v4, 4, v10
    v_add_u32 v3, s42, v4
    s_mul_i32 s42, s32, 320
    s_mul_i32 s43, s26, 5120
    s_add_u32 s42, s42, s43
    s_add_u32 s42, s42, 2621440
    v_lshrrev_b32 v11, 5, v1
    v_mul_u32_u24 v5, 10240, v11
    v_add3_u32 v4, v4, v5, s42
    v_add_u32 v5, 20480, v4
    s_lshl_b32 s42, s26, 2
    s_add_u32 s42, s42, 156928
    v_mov_b32 v12, s42
    v_mov_b32 v13, 0xdddd
    s_mul_i32 s56, s25, 40960
    s_add_u32 s56, s56, 3670016
    s_add_u32 s57, s56, 2621440
    s_mul_i32 s66, s31, 163840
    s_add_u32 s66, s66, s56
    s_add_u32 s42, s25, 1
    s_and_b32 s42, s42, 3
    s_lshl_b32 s43, s31, 2
    s_add_u32 s42, s42, s43
    s_mul_i32 s42, s42, 40960
    s_add_u32 s44, s42, 1048576
    s_add_u32 s42, s25, 2
    s_and_b32 s42, s42, 3
    s_lshl_b32 s43, s31, 2
    s_add_u32 s42, s42, s43
    s_mul_i32 s42, s42, 40960
    s_add_u32 s45, s42, 1048576
    s_add_u32 s42, s25, 3
    s_and_b32 s42, s42, 3
    s_lshl_b32 s43, s31, 2
    s_add_u32 s42, s42, s43
    s_mul_i32 s42, s42, 40960
    s_add_u32 s46, s42, 1048576
    s_add_u32 s42, s25, 4
    s_and_b32 s42, s42, 3
    s_lshl_b32 s43, s31, 2
    s_add_u32 s42, s42, s43
    s_mul_i32 s42, s42, 40960
    s_add_u32 s47, s42, 1048576
    s_mul_i32 s42, s32, 20
    s_add_u32 s43, s42, 19
    s_lshr_b32 s42, s42, 6
    s_lshr_b32 s43, s43, 6
    s_sub_u32 s43, s43, s42
    v_and_b32 v15, 1, v1
    v_mul_u32_u24 v15, s43, v15
    v_add_u32 v15, s42, v15
    v_bfe_u32 v14, v1, 1, 1
    v_mul_u32_u24 v14, 5, v14
    v_add3_u32 v14, v14, v15, 5
    v_lshrrev_b32 v19, 2, v1
    v_lshl_add_u32 v14, v19, 4, v14
    v_lshlrev_b32 v14, 7, v14
    v_lshlrev_b32 v15, 7, v15
    v_mov_b32 v248, v14
    s_lshl_b32 s48, s26, 15
    s_add_u32 s48, s48, 655360
    s_lshl_b32 s49, s31, 11
    s_add_u32 s49, s49, s48
    v_mov_b32 v96, 0
    v_mov_b32 v97, 0
    v_mov_b32 v98, 0
    v_mov_b32 v99, 0
    v_mov_b32 v100, 0
    v_mov_b32 v101, 0
    v_mov_b32 v102, 0
    v_mov_b32 v103, 0
    v_mov_b32 v104, 0
    v_mov_b32 v105, 0
    v_mov_b32 v106, 0
    v_mov_b32 v107, 0
    v_mov_b32 v108, 0
    v_mov_b32 v109, 0
    v_mov_b32 v110, 0
    v_mov_b32 v111, 0
    v_mov_b32 v112, 0
    v_mov_b32 v113, 0
    v_mov_b32 v114, 0
    v_mov_b32 v115, 0
    v_mov_b32 v116, 0
    v_mov_b32 v117, 0
    v_mov_b32 v118, 0
    v_mov_b32 v119, 0
    v_mov_b32 v120, 0
    v_mov_b32 v121, 0
    v_mov_b32 v122, 0
    v_mov_b32 v123, 0
    v_mov_b32 v124, 0
    v_mov_b32 v125, 0
    v_mov_b32 v126, 0
    v_mov_b32 v127, 0
    v_mov_b32 v128, 0
    v_mov_b32 v129, 0
    v_mov_b32 v130, 0
    v_mov_b32 v131, 0
    v_mov_b32 v132, 0
    v_mov_b32 v133, 0
    v_mov_b32 v134, 0
    v_mov_b32 v135, 0
    v_mov_b32 v136, 0
    v_mov_b32 v137, 0
    v_mov_b32 v138, 0
    v_mov_b32 v139, 0
    v_mov_b32 v140, 0
    v_mov_b32 v141, 0
    v_mov_b32 v142, 0
    v_mov_b32 v143, 0
    v_mov_b32 v144, 0
    v_mov_b32 v145, 0
    v_mov_b32 v146, 0
    v_mov_b32 v147, 0
    v_mov_b32 v148, 0
    v_mov_b32 v149, 0
    v_mov_b32 v150, 0
    v_mov_b32 v151, 0
    v_mov_b32 v152, 0
    v_mov_b32 v153, 0
    v_mov_b32 v154, 0
    v_mov_b32 v155, 0
    v_mov_b32 v156, 0
    v_mov_b32 v157, 0
    v_mov_b32 v158, 0
    v_mov_b32 v159, 0
    s_mov_b32 vcc_lo, 0x100000
    s_mov_b32 vcc_hi, 0x100000
    v_mov_b32 v19, 0x3f803f80
    v_cndmask_b32 v19, 0, v19, vcc
    v_mov_b32 v172, 0x3f803f80
    v_mov_b32 v173, 0x3f80
    v_mov_b32 v164, v19
    v_mov_b32 v165, v19
    v_mov_b32 v166, v19
    v_mov_b32 v167, v19
    v_mov_b32 v168, v19
    v_mov_b32 v169, v19
    v_mov_b32 v170, v19
    v_mov_b32 v171, v19
    v_mov_b32 v188, 0x3f803f80
    v_mov_b32 v189, 0x3f80
    v_mov_b32 v180, v19
    v_mov_b32 v181, v19
    v_mov_b32 v182, v19
    v_mov_b32 v183, v19
    v_mov_b32 v184, v19
    v_mov_b32 v185, v19
    v_mov_b32 v186, v19
    v_mov_b32 v187, v19
    v_mov_b32 v204, 0x3f803f80
    v_mov_b32 v205, 0x3f80
    v_mov_b32 v196, v19
    v_mov_b32 v197, v19
    v_mov_b32 v198, v19
    v_mov_b32 v199, v19
    v_mov_b32 v200, v19
    v_mov_b32 v201, v19
    v_mov_b32 v202, v19
    v_mov_b32 v203, v19
    v_mov_b32 v220, 0x3f803f80
    v_mov_b32 v221, 0x3f80
    v_mov_b32 v212, v19
    v_mov_b32 v213, v19
    v_mov_b32 v214, v19
    v_mov_b32 v215, v19
    v_mov_b32 v216, v19
    v_mov_b32 v217, v19
    v_mov_b32 v218, v19
    v_mov_b32 v219, v19
    v_mov_b32 v32, 0
    s_mov_b32 s43, 4096
    s_cmp_lg_u32 s24, 0
    s_cbranch_scc1 L_selw
    s_mov_b32 s68, 0x100000
L_pl_35:
    buffer_load_dword v252, v32, s[12:15], s43 offen sc1
    s_sub_u32 s68, s68, 1
    s_waitcnt vmcnt(0)
    s_cbranch_scc1 L_pld_36
    v_cmp_ne_u32 vcc, s27, v252
    s_cbranch_vccz L_pld_36
    s_sleep 16
    s_branch L_pl_35
L_pld_36:
L_selw:
    s_barrier
    s_cmp_eq_u32 s26, 0
    s_cbranch_scc1 L_ga
    v_mov_b32 v255, 5
    s_add_u32 s64, s64, 20
    s_waitcnt lgkmcnt(0)
    s_mov_b64 exec, 1
    ds_add_rtn_u32 v255, v12, v255
    s_mov_b64 exec, -1
    s_waitcnt lgkmcnt(0)
    v_readfirstlane_b32 s40, v255
    s_add_u32 s40, s40, 5
    s_cmp_ge_u32 s40, s64
    s_cbranch_scc1 L_gs_37
    s_mov_b32 s68, 0x2000000
L_lw_38:
    ds_read_b32 v255, v12
    s_sub_u32 s68, s68, 1
    s_cbranch_scc1 L_lwd_39
    s_waitcnt lgkmcnt(0)
    v_readfirstlane_b32 s40, v255
    s_cmp_ge_u32 s40, s64
    s_cbranch_scc1 L_lwd_39
    s_sleep 0
    s_branch L_lw_38
L_lwd_39:
    s_waitcnt lgkmcnt(0)
L_gs_37:
L_m1:
    s_setprio 3
    v_mov_b32 v32, 0
    s_mov_b32 s43, 4096
    s_mov_b32 s68, 0x100000
L_pl_40:
    buffer_load_dword v252, v32, s[12:15], s43 offen sc1
    s_sub_u32 s68, s68, 1
    s_waitcnt vmcnt(0)
    s_cbranch_scc1 L_pld_41
    v_cmp_ne_u32 vcc, s27, v252
    s_cbranch_vccz L_pld_41
    s_sleep 8
    s_branch L_pl_40
L_pld_41:
L_m1f:
    s_setprio 3
    v_mov_b32 v254, 156928
    s_mov_b32 s68, 0x2000000
L_lw_42:
    ds_read_b32 v255, v254
    s_sub_u32 s68, s68, 1
    s_cbranch_scc1 L_lwd_43
    s_waitcnt lgkmcnt(0)
    v_readfirstlane_b32 s40, v255
    s_cmp_ge_u32 s40, 4
    s_cbranch_scc1 L_lwd_43
    s_sleep 4
    s_branch L_lw_42
L_lwd_43:
    s_waitcnt lgkmcnt(0)
    s_lshr_b32 s40, s25, 1
    s_lshl_b32 s40, s40, 3
    s_add_u32 s40, s40, 40
    s_load_dwordx2 s[20:21], s[0:1], s40
    s_mov_b32 s22, 1966080
    v_lshrrev_b32 v34, 2, v1
    v_mul_u32_u24 v34, 3072, v34
    v_and_b32 v35, 3, v1
    v_lshl_add_u32 v34, v35, 4, v34
    s_mul_i32 s40, s50, 196608
    s_lshl_b32 s41, s51, 7
    s_add_u32 s40, s40, s41
    s_and_b32 s41, s25, 1
    s_lshl_b32 s41, s41, 6
    s_add_u32 s40, s40, s41
    s_lshl_b32 s41, s25, 12
    s_add_u32 s41, s41, 140544
    s_waitcnt lgkmcnt(0)
    s_cmp_ge_u32 s2, 240
    s_cbranch_scc1 L_m1s_44
    s_add_u32 m0, s41, 0
    s_nop 0
    buffer_load_dwordx4 v34, s[20:23], s40 offen nt lds
    s_add_u32 s40, s40, 49152
    s_waitcnt vmcnt(1)
    s_add_u32 m0, s41, 1024
    s_nop 0
    buffer_load_dwordx4 v34, s[20:23], s40 offen nt lds
    s_add_u32 s40, s40, 49152
    s_waitcnt vmcnt(1)
    s_add_u32 m0, s41, 2048
    s_nop 0
    buffer_load_dwordx4 v34, s[20:23], s40 offen nt lds
    s_add_u32 s40, s40, 49152
    s_waitcnt vmcnt(1)
    s_add_u32 m0, s41, 3072
    s_nop 0
    buffer_load_dwordx4 v34, s[20:23], s40 offen nt lds
    s_add_u32 s40, s40, 49152
L_m1s_44:
    s_cmp_ge_u32 s2, 240
    s_cbranch_scc1 L_m1d_45
    v_and_b32 v32, 1, v1
    v_mul_u32_u24 v32, 1280, v32
    v_lshl_add_u32 v32, v11, 4, v32
    s_lshl_b32 s40, s50, 7
    s_add_u32 s40, s40, 98304
    buffer_load_dwordx4 v[48:51], v32, s[12:15], s40 offen offset:0 sc1
    buffer_load_dwordx4 v[52:55], v32, s[12:15], s40 offen offset:32 sc1
    buffer_load_dwordx4 v[56:59], v32, s[12:15], s40 offen offset:64 sc1
    buffer_load_dwordx4 v[60:63], v32, s[12:15], s40 offen offset:96 sc1
    v_bfe_u32 v34, v1, 2, 2
    v_lshl_add_u32 v33, v11, 3, v34
    v_lshlrev_b32 v33, 6, v33
    v_bfe_u32 v34, v1, 4, 1
    v_lshl_add_u32 v33, v34, 5, v33
    v_and_b32 v35, 3, v1
    v_lshl_add_u32 v33, v35, 3, v33
    s_lshl_b32 s41, s25, 12
    s_add_u32 s41, s41, 140544
    v_add_u32 v33, s41, v33
    v_lshlrev_b32 v34, 3, v1
    s_waitcnt vmcnt(4)
    ds_read_b64_tr_b16 v[64:65], v33 offset:0
    ds_read_b64_tr_b16 v[66:67], v33 offset:256
    ds_read_b64_tr_b16 v[68:69], v33 offset:1024
    ds_read_b64_tr_b16 v[70:71], v33 offset:1280
    ds_read_b64_tr_b16 v[72:73], v33 offset:2048
    ds_read_b64_tr_b16 v[74:75], v33 offset:2304
    ds_read_b64_tr_b16 v[76:77], v33 offset:3072
    ds_read_b64_tr_b16 v[78:79], v33 offset:3328
    s_mul_i32 s40, s51, 10
    s_add_u32 s40, s40, s50
    s_lshl_b32 s40, s40, 2
    s_add_u32 s40, s40, s25
    s_lshl_b32 s40, s40, 8
    s_add_u32 s40, s40, 131072
    s_waitcnt vmcnt(0) lgkmcnt(0)
    v_mfma_f32_32x32x16_bf16 v[80:95], v[48:51], v[64:67], 0
    v_mfma_f32_32x32x16_bf16 v[80:95], v[52:55], v[68:71], v[80:95]
    v_mfma_f32_32x32x16_bf16 v[80:95], v[56:59], v[72:75], v[80:95]
    v_mfma_f32_32x32x16_bf16 v[80:95], v[60:63], v[76:79], v[80:95]
    s_nop 11
    s_mov_b64 exec, s[60:61]
    buffer_store_dwordx2 v[80:81], v34, s[12:15], s40 offen sc1
    s_mov_b64 exec, -1
L_m1d_45:
    s_waitcnt vmcnt(0)
    v_mov_b32 v255, 1
    s_add_u32 s64, s64, 4
    s_waitcnt lgkmcnt(0)
    s_mov_b64 exec, 1
    ds_add_rtn_u32 v255, v12, v255
    s_mov_b64 exec, -1
    s_waitcnt lgkmcnt(0)
    v_readfirstlane_b32 s40, v255
    s_add_u32 s40, s40, 1
    s_cmp_ge_u32 s40, s64
    s_cbranch_scc1 L_gs_46
    s_mov_b32 s68, 0x2000000
L_lw_47:
    ds_read_b32 v255, v12
    s_sub_u32 s68, s68, 1
    s_cbranch_scc1 L_lwd_48
    s_waitcnt lgkmcnt(0)
    v_readfirstlane_b32 s40, v255
    s_cmp_ge_u32 s40, s64
    s_cbranch_scc1 L_lwd_48
    s_sleep 0
    s_branch L_lw_47
L_lwd_48:
    s_waitcnt lgkmcnt(0)
L_gs_46:
    s_cmp_lg_u32 s24, 4
    s_cbranch_scc1 L_m1f_49
    s_cmp_ge_u32 s2, 240
    s_cbranch_scc1 L_m1f_49
    s_mul_i32 s41, s51, 10
    s_add_u32 s41, s41, s50
    s_lshl_b32 s41, s41, 7
    s_add_u32 s42, s41, 786432
    v_mov_b32 v255, s27
    v_mov_b32 v254, 0
    s_mov_b64 exec, 1
    buffer_store_dword v255, v254, s[12:15], s42 offen sc1
    s_mov_b64 exec, -1
L_m1f_49:
    v_add_u32 v251, 16, v12
    s_cmp_lg_u32 s25, 0
    s_cbranch_scc1 L_f1wb
    v_mov_b32 v254, 156944
    s_mov_b32 s68, 0x2000000
L_lw_50:
    ds_read_b32 v255, v254
    s_sub_u32 s68, s68, 1
    s_cbranch_scc1 L_lwd_51
    s_waitcnt lgkmcnt(0)
    v_readfirstlane_b32 s40, v255
    s_cmp_ge_u32 s40, 1
    s_cbranch_scc1 L_lwd_51
    s_sleep 8
    s_branch L_lw_50
L_lwd_51:
    s_waitcnt lgkmcnt(0)
    s_mov_b32 s68, 0x100000
L_pl_52:
    buffer_load_dword v252, v14, s[12:15], s48 offen sc1
    buffer_load_dword v253, v15, s[12:15], s49 offen sc1
    s_sub_u32 s68, s68, 1
    s_waitcnt vmcnt(0)
    s_cbranch_scc1 L_pld_53
    v_cmp_ne_u32 vcc, s27, v252
    v_cmp_ne_u32 s[40:41], s27, v253
    s_or_b64 vcc, vcc, s[40:41]
    s_cbranch_vccz L_pld_53
    s_sleep 8
    s_branch L_pl_52
L_pld_53:
    v_mov_b32 v255, 1
    s_waitcnt lgkmcnt(0)
    s_mov_b64 exec, 1
    ds_add_u32 v251, v255
    s_mov_b64 exec, -1
    s_branch L_f1d
L_f1wb:
    s_mov_b32 s68, 0x2000000
L_lw_54:
    ds_read_b32 v255, v251
    s_sub_u32 s68, s68, 1
    s_cbranch_scc1 L_lwd_55
    s_waitcnt lgkmcnt(0)
    v_readfirstlane_b32 s40, v255
    s_cmp_ge_u32 s40, 1
    s_cbranch_scc1 L_lwd_55
    s_sleep 8
    s_branch L_lw_54
L_lwd_55:
    s_waitcnt lgkmcnt(0)
    s_branch L_f1d
L_ga:
    v_add_u32 v251, 16, v12
    s_cmp_lg_u32 s25, 0
    s_cbranch_scc1 L_f1w
    v_lshrrev_b32 v249, 2, v1
    v_subrev_u32 v249, s31, v249
    v_and_b32 v249, 15, v249
    v_cmp_gt_u32 vcc, 3, v249
    s_mov_b64 exec, vcc
    s_mov_b32 s68, 0x100000
L_pl_56:
    buffer_load_dword v252, v14, s[12:15], s48 offen sc1
    buffer_load_dword v253, v15, s[12:15], s49 offen sc1
    s_sub_u32 s68, s68, 1
    s_waitcnt vmcnt(0)
    s_cbranch_scc1 L_pld_57
    v_cmp_ne_u32 vcc, s27, v252
    v_cmp_ne_u32 s[40:41], s27, v253
    s_or_b64 vcc, vcc, s[40:41]
    s_cbranch_vccz L_pld_57
    s_sleep 0
    s_branch L_pl_56
L_pld_57:
    s_mov_b64 exec, -1
    v_mov_b32 v255, 1
    s_waitcnt lgkmcnt(0)
    s_mov_b64 exec, 1
    ds_add_u32 v251, v255
    s_mov_b64 exec, -1
    s_branch L_f1d
L_f1w:
    s_mov_b32 s68, 0x2000000
L_lw_58:
    ds_read_b32 v255, v251
    s_sub_u32 s68, s68, 1
    s_cbranch_scc1 L_lwd_59
    s_waitcnt lgkmcnt(0)
    v_readfirstlane_b32 s40, v255
    s_cmp_ge_u32 s40, 1
    s_cbranch_scc1 L_lwd_59
    s_sleep 0
    s_branch L_lw_58
L_lwd_59:
    s_waitcnt lgkmcnt(0)
L_f1d:
    s_mov_b32 s20, s12
    s_mov_b32 s21, s13
    s_mov_b32 s22, 0x10000000
    v_mov_b32 v246, 0
    v_mov_b32 v247, 0
    buffer_load_dwordx4 v[236:239], v2, s[12:15], s47 offen sc1
    buffer_load_dwordx4 v[160:163], v2, s[20:23], s66 offen sc1
    s_mov_b64 exec, s[60:61]
    buffer_load_dwordx2 v[246:247], v3, s[12:15], s47 offen sc1
    buffer_load_dwordx2 v[172:173], v3, s[20:23], s66 offen sc1
    s_mov_b64 exec, -1
    s_lshl_b32 s40, s26, 10
    s_add_u32 s40, s40, 157184
    v_lshl_add_u32 v16, v10, 3, s40
    v_lshlrev_b32 v9, 4, v1
    v_add_u32 v9, 103680, v9
    s_add_u32 s41, s25, 1
    s_and_b32 s41, s41, 3
    s_lshl_b32 s42, s41, 8
    v_add_u32 v17, s42, v16
    s_mul_i32 s41, s41, 9216
    v_add_u32 v6, s41, v9
    s_add_u32 s41, s25, 2
    s_and_b32 s41, s41, 3
    s_lshl_b32 s42, s41, 8
    v_add_u32 v18, s42, v16
    s_mul_i32 s41, s41, 9216
    v_add_u32 v7, s41, v9
    s_add_u32 s41, s25, 3
    s_and_b32 s41, s41, 3
    s_lshl_b32 s42, s41, 8
    v_add_u32 v19, s42, v16
    s_mul_i32 s41, s41, 9216
    v_add_u32 v8, s41, v9
    s_add_u32 s41, s25, 4
    s_and_b32 s41, s41, 3
    s_lshl_b32 s42, s41, 8
    v_add_u32 v20, s42, v16
    s_mul_i32 s41, s25, 9216
    v_add_u32 v9, s41, v9
    v_lshrrev_b32 v22, 4, v10
    s_lshl_b32 s40, s31, 3
    s_lshl_b32 s41, s25, 1
    s_add_u32 s40, s40, s41
    v_add_u32 v22, s40, v22
    v_and_b32 v23, 15, v1
    v_lshlrev_b32 v14, 14, v22
    v_lshl_add_u32 v14, v23, 4, v14
    v_lshl_add_u32 v14, v11, 8, v14
    s_lshl_b32 s52, s26, 13
    s_lshl_b32 s53, s32, 9
    s_add_u32 s52, s52, s53
    s_add_u32 s52, s52, 11534336
    v_lshlrev_b32 v15, 12, v22
    v_lshl_add_u32 v15, v23, 3, v15
    s_lshl_b32 s53, s26, 4
    s_add_u32 s53, s53, s32
    s_lshl_b32 s53, s53, 7
    s_add_u32 s53, s53, 13631488
    s_mov_b32 s59, 0
    v_mov_b32 v88, 0
    v_mov_b32 v89, 0
    v_mov_b32 v90, 0
    v_mov_b32 v91, 0
    v_mov_b32 v92, 0
    v_mov_b32 v93, 0
    v_mov_b32 v94, 0
    v_mov_b32 v95, 0
    s_mov_b64 exec, s[60:61]
    buffer_load_dwordx2 v[240:241], v3, s[12:15], s44 offen sc1
    buffer_load_dwordx2 v[242:243], v3, s[12:15], s45 offen sc1
    buffer_load_dwordx2 v[244:245], v3, s[12:15], s46 offen sc1
    s_mov_b64 exec, -1
    buffer_load_dwordx4 v[224:227], v2, s[12:15], s44 offen sc1
    buffer_load_dwordx4 v[228:231], v2, s[12:15], s45 offen sc1
    buffer_load_dwordx4 v[232:235], v2, s[12:15], s46 offen sc1
    s_mov_b64 exec, s[62:63]
    buffer_load_dwordx4 v[164:167], v4, s[20:23], s66 offen sc1
    buffer_load_dwordx4 v[168:171], v5, s[20:23], s66 offen sc1
    s_mov_b64 exec, -1
    s_add_u32 s66, s66, 163840
    s_cmp_eq_u32 s66, s57
    s_cselect_b32 s66, s56, s66
    buffer_load_dwordx4 v[176:179], v2, s[20:23], s66 offen sc1
    s_mov_b64 exec, s[60:61]
    buffer_load_dwordx2 v[188:189], v3, s[20:23], s66 offen sc1
    s_mov_b64 exec, s[62:63]
    buffer_load_dwordx4 v[180:183], v4, s[20:23], s66 offen sc1
    buffer_load_dwordx4 v[184:187], v5, s[20:23], s66 offen sc1
    s_mov_b64 exec, -1
    s_add_u32 s66, s66, 163840
    s_cmp_eq_u32 s66, s57
    s_cselect_b32 s66, s56, s66
    buffer_load_dwordx4 v[192:195], v2, s[20:23], s66 offen sc1
    s_mov_b64 exec, s[60:61]
    buffer_load_dwordx2 v[204:205], v3, s[20:23], s66 offen sc1
    s_mov_b64 exec, s[62:63]
    buffer_load_dwordx4 v[196:199], v4, s[20:23], s66 offen sc1
    buffer_load_dwordx4 v[200:203], v5, s[20:23], s66 offen sc1
    s_mov_b64 exec, -1
    s_add_u32 s66, s66, 163840
    s_cmp_eq_u32 s66, s57
    s_cselect_b32 s66, s56, s66
    s_cmp_lg_u32 s24, 0
    s_cbranch_scc1 L_np1
    buffer_load_dword v252, v248, s[12:15], s48 offen sc1
L_np1:
    s_waitcnt vmcnt(16)
    v_mfma_f32_32x32x8_bf16 v[32:47], v[172:173], v[246:247], 0
    v_mfma_f32_32x32x16_bf16 v[32:47], v[160:163], v[236:239], v[32:47]
    s_nop 11
    v_max3_f32 v22, v32, v33, v34
    v_max3_f32 v35, v35, v36, v37
    v_max3_f32 v38, v38, v39, v40
    v_max3_f32 v41, v41, v42, v43
    v_max3_f32 v44, v44, v45, v46
    v_max3_f32 v22, v22, v35, v38
    v_max3_f32 v41, v41, v44, v47
    v_mov_b32 v25, 0
    v_max_f32 v22, v22, v41
    v_mov_b32 v23, v22
    s_nop 1
    v_permlane32_swap_b32 v22, v23
    s_nop 1
    v_max_f32 v22, v22, v23
    v_add_f32 v22, 0x42200000, v22
    v_cvt_pk_bf16_f32 v24, -v22, 0
    s_not_b64 exec, s[60:61]
    ds_write_b64 v20, v[24:25]
    s_mov_b64 exec, -1
    s_cmp_lg_u32 s24, 0
    s_cbranch_scc1 L_np2
    s_waitcnt vmcnt(0)
    v_cmp_ne_u32 vcc, s27, v252
    s_cbranch_vccz L_np2
    s_mov_b32 s68, 0x100000
L_pl_60:
    buffer_load_dword v252, v248, s[12:15], s48 offen sc1
    s_sub_u32 s68, s68, 1
    s_waitcnt vmcnt(0)
    s_cbranch_scc1 L_pld_61
    v_cmp_ne_u32 vcc, s27, v252
    s_cbranch_vccz L_pld_61
    s_sleep 0
    s_branch L_pl_60
L_pld_61:
L_np2:
    v_mov_b32 v255, 1
    s_add_u32 s64, s64, 4
    s_waitcnt lgkmcnt(0)
    s_mov_b64 exec, 1
    ds_add_rtn_u32 v255, v12, v255
    s_mov_b64 exec, -1
    s_waitcnt lgkmcnt(0)
    v_readfirstlane_b32 s40, v255
    s_add_u32 s40, s40, 1
    s_cmp_ge_u32 s40, s64
    s_cbranch_scc1 L_gs_62
    s_mov_b32 s68, 0x2000000
L_lw_63:
    ds_read_b32 v255, v12
    s_sub_u32 s68, s68, 1
    s_cbranch_scc1 L_lwd_64
    s_waitcnt lgkmcnt(0)
    v_readfirstlane_b32 s40, v255
    s_cmp_ge_u32 s40, s64
    s_cbranch_scc1 L_lwd_64
    s_sleep 0
    s_branch L_lw_63
L_lwd_64:
    s_waitcnt lgkmcnt(0)
L_gs_62:
    s_waitcnt vmcnt(10)
    s_not_b64 exec, s[60:61]
    ds_read_b64 v[240:241], v17
    ds_read_b64 v[242:243], v18
    ds_read_b64 v[244:245], v19
    ds_read_b64 v[246:247], v20
    s_mov_b64 exec, -1
    s_cmp_lg_u32 s24, 4
    s_cbranch_scc1 L_m2d
    s_cmp_ge_u32 s2, 240
    s_cbranch_scc1 L_m2d
    s_load_dwordx2 s[20:21], s[0:1], 56
    s_waitcnt lgkmcnt(0)
    s_mov_b32 s22, 1966080
    v_lshrrev_b32 v37, 3, v1
    v_lshrrev_b32 v38, 2, v1
    v_and_b32 v38, 4, v38
    v_xor_b32 v38, v38, v1
    v_and_b32 v38, 7, v38
    v_mul_u32_u24 v40, 1280, v37
    v_lshl_add_u32 v40, v38, 4, v40
    s_mul_i32 s40, s51, 81920
    s_lshl_b32 s41, s50, 7
    s_add_u32 s40, s40, s41
    s_mov_b32 m0, 140544
    s_nop 0
    buffer_load_dwordx4 v40, s[20:23], s40 offen nt lds
    s_add_u32 s40, s40, 10240
    s_mov_b32 m0, 141568
    s_nop 0
    buffer_load_dwordx4 v40, s[20:23], s40 offen nt lds
    s_add_u32 s40, s40, 10240
    s_mov_b32 m0, 142592
    s_nop 0
    buffer_load_dwordx4 v40, s[20:23], s40 offen nt lds
    s_add_u32 s40, s40, 10240
    s_mov_b32 m0, 143616
    s_nop 0
    buffer_load_dwordx4 v40, s[20:23], s40 offen nt lds
    s_add_u32 s40, s40, 10240
    s_mov_b32 m0, 144640
    s_nop 0
    buffer_load_dwordx4 v40, s[20:23], s40 offen nt lds
    s_add_u32 s40, s40, 10240
    s_mov_b32 m0, 145664
    s_nop 0
    buffer_load_dwordx4 v40, s[20:23], s40 offen nt lds
    s_add_u32 s40, s40, 10240
    s_mov_b32 m0, 146688
    s_nop 0
    buffer_load_dwordx4 v40, s[20:23], s40 offen nt lds
    s_add_u32 s40, s40, 10240
    s_mov_b32 m0, 147712
    s_nop 0
    buffer_load_dwordx4 v40, s[20:23], s40 offen nt lds
    s_add_u32 s40, s40, 10240
    v_min_u32 v41, 9, v1
    v_lshlrev_b32 v41, 7, v41
    s_mul_i32 s43, s51, 1280
    s_add_u32 s43, s43, 786432
    v_lshlrev_b32 v36, 3, v1
    s_mov_b32 s68, 0x100000
L_pl_65:
    buffer_load_dword v252, v41, s[12:15], s43 offen sc1
    s_sub_u32 s68, s68, 1
    s_waitcnt vmcnt(0)
    s_cbranch_scc1 L_pld_66
    v_cmp_ne_u32 vcc, s27, v252
    s_cbranch_vccz L_pld_66
    s_sleep 4
    s_branch L_pl_65
L_pld_66:
    s_mul_i32 s40, s51, 10240
    s_add_u32 s40, s40, 131072
    buffer_load_dwordx2 v[42:43], v36, s[12:15], s40 offen sc1
    buffer_load_dwordx2 v[44:45], v36, s[12:15], s40 offen offset:512 sc1
    s_add_u32 s40, s40, 1024
    buffer_load_dwordx2 v[46:47], v36, s[12:15], s40 offen sc1
    buffer_load_dwordx2 v[48:49], v36, s[12:15], s40 offen offset:512 sc1
    s_add_u32 s40, s40, 1024
    buffer_load_dwordx2 v[50:51], v36, s[12:15], s40 offen sc1
    buffer_load_dwordx2 v[52:53], v36, s[12:15], s40 offen offset:512 sc1
    s_add_u32 s40, s40, 1024
    buffer_load_dwordx2 v[54:55], v36, s[12:15], s40 offen sc1
    buffer_load_dwordx2 v[56:57], v36, s[12:15], s40 offen offset:512 sc1
    s_add_u32 s40, s40, 1024
    buffer_load_dwordx2 v[58:59], v36, s[12:15], s40 offen sc1
    buffer_load_dwordx2 v[60:61], v36, s[12:15], s40 offen offset:512 sc1
    s_add_u32 s40, s40, 1024
    buffer_load_dwordx2 v[62:63], v36, s[12:15], s40 offen sc1
    buffer_load_dwordx2 v[64:65], v36, s[12:15], s40 offen offset:512 sc1
    s_add_u32 s40, s40, 1024
    buffer_load_dwordx2 v[66:67], v36, s[12:15], s40 offen sc1
    buffer_load_dwordx2 v[68:69], v36, s[12:15], s40 offen offset:512 sc1
    s_add_u32 s40, s40, 1024
    buffer_load_dwordx2 v[70:71], v36, s[12:15], s40 offen sc1
    buffer_load_dwordx2 v[72:73], v36, s[12:15], s40 offen offset:512 sc1
    s_add_u32 s40, s40, 1024
    buffer_load_dwordx2 v[74:75], v36, s[12:15], s40 offen sc1
    buffer_load_dwordx2 v[76:77], v36, s[12:15], s40 offen offset:512 sc1
    s_add_u32 s40, s40, 1024
    buffer_load_dwordx2 v[78:79], v36, s[12:15], s40 offen sc1
    buffer_load_dwordx2 v[80:81], v36, s[12:15], s40 offen offset:512 sc1
    s_add_u32 s40, s40, 1024
    v_bfe_u32 v33, v1, 2, 2
    v_lshrrev_b32 v32, 5, v1
    v_lshl_add_u32 v32, v32, 3, v33
    v_lshlrev_b32 v32, 7, v32
    v_lshrrev_b32 v33, 1, v33
    v_lshl_add_u32 v32, v33, 6, v32
    v_bfe_u32 v33, v1, 4, 1
    v_lshl_add_u32 v32, v33, 5, v32
    v_and_b32 v33, 3, v1
    v_lshl_add_u32 v32, v33, 3, v32
    v_add_u32 v32, 140544, v32
    v_and_b32 v33, 1, v1
    v_lshlrev_b32 v33, 7, v33
    v_lshl_add_u32 v33, v11, 4, v33
    v_add_u32 v33, 159232, v33
    v_lshlrev_b32 v34, 1, v1
    v_add_u32 v34, 159232, v34
    v_xor_b32 v35, 64, v32
    s_waitcnt vmcnt(0)
    v_pk_add_f32 v[42:43], v[42:43], v[46:47]
    v_pk_add_f32 v[44:45], v[44:45], v[48:49]
    v_pk_add_f32 v[42:43], v[42:43], v[50:51]
    v_pk_add_f32 v[44:45], v[44:45], v[52:53]
    v_pk_add_f32 v[42:43], v[42:43], v[54:55]
    v_pk_add_f32 v[44:45], v[44:45], v[56:57]
    v_pk_add_f32 v[42:43], v[42:43], v[58:59]
    v_pk_add_f32 v[44:45], v[44:45], v[60:61]
    v_pk_add_f32 v[42:43], v[42:43], v[62:63]
    v_pk_add_f32 v[44:45], v[44:45], v[64:65]
    v_pk_add_f32 v[42:43], v[42:43], v[66:67]
    v_pk_add_f32 v[44:45], v[44:45], v[68:69]
    v_pk_add_f32 v[42:43], v[42:43], v[70:71]
    v_pk_add_f32 v[44:45], v[44:45], v[72:73]
    v_pk_add_f32 v[42:43], v[42:43], v[74:75]
    v_pk_add_f32 v[44:45], v[44:45], v[76:77]
    v_pk_add_f32 v[42:43], v[42:43], v[78:79]
    v_pk_add_f32 v[44:45], v[44:45], v[80:81]
    v_cvt_pk_bf16_f32 v42, v42, v42
    v_lshlrev_b32 v42, 16, v42
    v_cvt_pk_bf16_f32 v43, v43, v43
    v_lshlrev_b32 v43, 16, v43
    v_cvt_pk_bf16_f32 v44, v44, v44
    v_lshlrev_b32 v44, 16, v44
    v_cvt_pk_bf16_f32 v45, v45, v45
    v_lshlrev_b32 v45, 16, v45
    v_mul_f32 v46, 0xbfb8aa3b, v42
    v_exp_f32 v46, v46
    s_nop 0
    v_add_f32 v46, 1.0, v46
    v_rcp_f32 v46, v46
    s_nop 0
    v_mul_f32 v42, v42, v46
    v_cvt_pk_bf16_f32 v42, v42, v42
    v_lshlrev_b32 v42, 16, v42
    v_mul_f32 v42, v42, v44
    v_mul_f32 v46, 0xbfb8aa3b, v43
    v_exp_f32 v46, v46
    s_nop 0
    v_add_f32 v46, 1.0, v46
    v_rcp_f32 v46, v46
    s_nop 0
    v_mul_f32 v43, v43, v46
    v_cvt_pk_bf16_f32 v43, v43, v43
    v_lshlrev_b32 v43, 16, v43
    v_mul_f32 v43, v43, v45
    v_cvt_pk_bf16_f32 v42, v42, v43
    ds_write_b16 v34, v42
    ds_write_b16_d16_hi v34, v42 offset:128
    s_waitcnt lgkmcnt(0)
    v_mov_b32 v250, v36
    v_mov_b32 v248, v32
    v_mov_b32 v249, v35
    ds_read_b128 v[48:51], v33 offset:0
    ds_read_b128 v[52:55], v33 offset:32
    ds_read_b128 v[56:59], v33 offset:64
    ds_read_b128 v[60:63], v33 offset:96
    ds_read_b64_tr_b16 v[64:65], v248 offset:0
    ds_read_b64_tr_b16 v[66:67], v248 offset:512
    ds_read_b64_tr_b16 v[68:69], v248 offset:2048
    ds_read_b64_tr_b16 v[70:71], v248 offset:2560
    ds_read_b64_tr_b16 v[72:73], v248 offset:4096
    ds_read_b64_tr_b16 v[74:75], v248 offset:4608
    ds_read_b64_tr_b16 v[76:77], v248 offset:6144
    ds_read_b64_tr_b16 v[78:79], v248 offset:6656
    s_waitcnt lgkmcnt(0)
    v_mfma_f32_32x32x16_bf16 v[32:47], v[48:51], v[64:67], 0
    v_mfma_f32_32x32x16_bf16 v[32:47], v[52:55], v[68:71], v[32:47]
    v_mfma_f32_32x32x16_bf16 v[32:47], v[56:59], v[72:75], v[32:47]
    v_mfma_f32_32x32x16_bf16 v[32:47], v[60:63], v[76:79], v[32:47]
    ds_read_b64_tr_b16 v[64:65], v249 offset:0
    ds_read_b64_tr_b16 v[66:67], v249 offset:512
    ds_read_b64_tr_b16 v[68:69], v249 offset:2048
    ds_read_b64_tr_b16 v[70:71], v249 offset:2560
    ds_read_b64_tr_b16 v[72:73], v249 offset:4096
    ds_read_b64_tr_b16 v[74:75], v249 offset:4608
    ds_read_b64_tr_b16 v[76:77], v249 offset:6144
    ds_read_b64_tr_b16 v[78:79], v249 offset:6656
    s_waitcnt lgkmcnt(0)
    v_mfma_f32_32x32x16_bf16 v[80:95], v[48:51], v[64:67], 0
    v_mfma_f32_32x32x16_bf16 v[80:95], v[52:55], v[68:71], v[80:95]
    v_mfma_f32_32x32x16_bf16 v[80:95], v[56:59], v[72:75], v[80:95]
    v_mfma_f32_32x32x16_bf16 v[80:95], v[60:63], v[76:79], v[80:95]
    s_mul_i32 s41, s50, 24
    s_add_u32 s41, s41, s51
    s_lshl_b32 s40, s41, 9
    s_add_u32 s40, s40, 393216
    s_lshl_b32 s41, s41, 7
    s_add_u32 s42, s41, 851968
    s_nop 6
    s_mov_b64 exec, s[60:61]
    buffer_store_dwordx2 v[32:33], v250, s[12:15], s40 offen sc1
    buffer_store_dwordx2 v[80:81], v250, s[12:15], s40 offen offset:256 sc1
    s_mov_b64 exec, -1
    s_waitcnt vmcnt(0)
    v_mov_b32 v255, s27
    v_mov_b32 v254, 0
    s_mov_b64 exec, 1
    buffer_store_dword v255, v254, s[12:15], s42 offen sc1
    s_mov_b64 exec, -1
    v_mov_b32 v88, 0
    v_mov_b32 v89, 0
    v_mov_b32 v90, 0
    v_mov_b32 v91, 0
    v_mov_b32 v92, 0
    v_mov_b32 v93, 0
    v_mov_b32 v94, 0
    v_mov_b32 v95, 0
L_m2d:
    s_setprio 1
    s_cmp_eq_u32 s26, 0
    s_cbranch_scc1 L_main0
    s_setprio 0
L_main0:
    s_waitcnt lgkmcnt(0)
L_main:
    s_mov_b32 s20, s12
    s_mov_b32 s21, s13
    s_mov_b32 s22, 0x10000000
    v_mfma_f32_32x32x8_bf16 v[32:47], v[172:173], v[240:241], 0
    v_mfma_f32_32x32x16_bf16 v[32:47], v[160:163], v[224:227], v[32:47]
    s_mov_b32 s67, 4
    s_nop 9
    .p2align 6
L_loop:
    v_mfma_f32_32x32x8_bf16 v[48:63], v[172:173], v[242:243], 0
    v_exp_f32 v32, v32
    v_exp_f32 v33, v33
    v_exp_f32 v34, v34
    v_exp_f32 v35, v35
    v_mfma_f32_32x32x16_bf16 v[48:63], v[160:163], v[228:231], v[48:63]
    s_waitcnt vmcnt(8)
    v_exp_f32 v36, v36
    v_exp_f32 v37, v37
    v_exp_f32 v38, v38
    v_exp_f32 v39, v39
    v_smfmac_f32_32x32x32_bf16 v[144:159], v[216:219], v[88:95], v13
    buffer_load_dwordx4 v[208:211], v2, s[20:23], s66 offen sc1
    v_exp_f32 v40, v40
    v_exp_f32 v41, v41
    v_exp_f32 v42, v42
    v_exp_f32 v43, v43
    v_smfmac_f32_32x32x32_bf16 v[96:111], v[164:167], v[32:39], v13
    v_exp_f32 v44, v44
    v_exp_f32 v45, v45
    v_exp_f32 v46, v46
    v_exp_f32 v47, v47
    v_mfma_f32_32x32x8_bf16 v[64:79], v[172:173], v[244:245], 0
    v_exp_f32 v48, v48
    v_exp_f32 v49, v49
    v_exp_f32 v50, v50
    v_exp_f32 v51, v51
    v_mfma_f32_32x32x16_bf16 v[64:79], v[160:163], v[232:235], v[64:79]
    v_exp_f32 v52, v52
    v_exp_f32 v53, v53
    v_exp_f32 v54, v54
    v_exp_f32 v55, v55
    v_smfmac_f32_32x32x32_bf16 v[96:111], v[168:171], v[40:47], v13
    s_mov_b64 exec, s[60:61]
    buffer_load_dwordx2 v[220:221], v3, s[20:23], s66 offen sc1
    s_mov_b64 exec, -1
    v_exp_f32 v56, v56
    v_exp_f32 v57, v57
    v_exp_f32 v58, v58
    v_exp_f32 v59, v59
    v_smfmac_f32_32x32x32_bf16 v[112:127], v[164:167], v[48:55], v13
    v_exp_f32 v60, v60
    v_exp_f32 v61, v61
    v_exp_f32 v62, v62
    v_exp_f32 v63, v63
    v_mfma_f32_32x32x8_bf16 v[80:95], v[172:173], v[246:247], 0
    v_exp_f32 v64, v64
    v_exp_f32 v65, v65
    v_exp_f32 v66, v66
    v_exp_f32 v67, v67
    v_mfma_f32_32x32x16_bf16 v[80:95], v[160:163], v[236:239], v[80:95]
    v_exp_f32 v68, v68
    v_exp_f32 v69, v69
    v_exp_f32 v70, v70
    v_exp_f32 v71, v71
    v_smfmac_f32_32x32x32_bf16 v[112:127], v[168:171], v[56:63], v13
    s_mov_b64 exec, s[62:63]
    buffer_load_dwordx4 v[212:215], v4, s[20:23], s66 offen sc1
    s_mov_b64 exec, -1
    v_exp_f32 v72, v72
    v_exp_f32 v73, v73
    v_exp_f32 v74, v74
    v_exp_f32 v75, v75
    v_smfmac_f32_32x32x32_bf16 v[128:143], v[164:167], v[64:71], v13
    s_waitcnt vmcnt(9)
    v_exp_f32 v76, v76
    v_exp_f32 v77, v77
    v_exp_f32 v78, v78
    v_exp_f32 v79, v79
    v_mfma_f32_32x32x8_bf16 v[32:47], v[188:189], v[240:241], 0
    v_exp_f32 v80, v80
    v_exp_f32 v81, v81
    v_exp_f32 v82, v82
    v_exp_f32 v83, v83
    v_mfma_f32_32x32x16_bf16 v[32:47], v[176:179], v[224:227], v[32:47]
    v_exp_f32 v84, v84
    v_exp_f32 v85, v85
    v_exp_f32 v86, v86
    v_exp_f32 v87, v87
    v_smfmac_f32_32x32x32_bf16 v[128:143], v[168:171], v[72:79], v13
    s_mov_b64 exec, s[62:63]
    buffer_load_dwordx4 v[216:219], v5, s[20:23], s66 offen sc1
    s_mov_b64 exec, -1
    v_exp_f32 v88, v88
    v_exp_f32 v89, v89
    v_exp_f32 v90, v90
    v_exp_f32 v91, v91
    v_smfmac_f32_32x32x32_bf16 v[144:159], v[164:167], v[80:87], v13
    s_add_u32 s66, s66, 163840
    s_cmp_eq_u32 s66, s57
    s_cselect_b32 s66, s56, s66
    s_cmp_eq_u32 s67, 1
    s_cselect_b32 s22, 0, s22
    v_exp_f32 v92, v92
    v_exp_f32 v93, v93
    v_exp_f32 v94, v94
    v_exp_f32 v95, v95
    v_mfma_f32_32x32x8_bf16 v[48:63], v[188:189], v[242:243], 0
    v_exp_f32 v32, v32
    v_exp_f32 v33, v33
    v_exp_f32 v34, v34
    v_exp_f32 v35, v35
    v_mfma_f32_32x32x16_bf16 v[48:63], v[176:179], v[228:231], v[48:63]
    s_waitcnt vmcnt(8)
    v_exp_f32 v36, v36
    v_exp_f32 v37, v37
    v_exp_f32 v38, v38
    v_exp_f32 v39, v39
    v_smfmac_f32_32x32x32_bf16 v[144:159], v[168:171], v[88:95], v13
    buffer_load_dwordx4 v[160:163], v2, s[20:23], s66 offen sc1
    v_exp_f32 v40, v40
    v_exp_f32 v41, v41
    v_exp_f32 v42, v42
    v_exp_f32 v43, v43
    v_smfmac_f32_32x32x32_bf16 v[96:111], v[180:183], v[32:39], v13
    v_exp_f32 v44, v44
    v_exp_f32 v45, v45
    v_exp_f32 v46, v46
    v_exp_f32 v47, v47
    v_mfma_f32_32x32x8_bf16 v[64:79], v[188:189], v[244:245], 0
    v_exp_f32 v48, v48
    v_exp_f32 v49, v49
    v_exp_f32 v50, v50
    v_exp_f32 v51, v51
    v_mfma_f32_32x32x16_bf16 v[64:79], v[176:179], v[232:235], v[64:79]
    v_exp_f32 v52, v52
    v_exp_f32 v53, v53
    v_exp_f32 v54, v54
    v_exp_f32 v55, v55
    v_smfmac_f32_32x32x32_bf16 v[96:111], v[184:187], v[40:47], v13
    s_mov_b64 exec, s[60:61]
    buffer_load_dwordx2 v[172:173], v3, s[20:23], s66 offen sc1
    s_mov_b64 exec, -1
    v_exp_f32 v56, v56
    v_exp_f32 v57, v57
    v_exp_f32 v58, v58
    v_exp_f32 v59, v59
    v_smfmac_f32_32x32x32_bf16 v[112:127], v[180:183], v[48:55], v13
    v_exp_f32 v60, v60
    v_exp_f32 v61, v61
    v_exp_f32 v62, v62
    v_exp_f32 v63, v63
    v_mfma_f32_32x32x8_bf16 v[80:95], v[188:189], v[246:247], 0
    v_exp_f32 v64, v64
    v_exp_f32 v65, v65
    v_exp_f32 v66, v66
    v_exp_f32 v67, v67
    v_mfma_f32_32x32x16_bf16 v[80:95], v[176:179], v[236:239], v[80:95]
    v_exp_f32 v68, v68
    v_exp_f32 v69, v69
    v_exp_f32 v70, v70
    v_exp_f32 v71, v71
    v_smfmac_f32_32x32x32_bf16 v[112:127], v[184:187], v[56:63], v13
    s_mov_b64 exec, s[62:63]
    buffer_load_dwordx4 v[164:167], v4, s[20:23], s66 offen sc1
    s_mov_b64 exec, -1
    v_exp_f32 v72, v72
    v_exp_f32 v73, v73
    v_exp_f32 v74, v74
    v_exp_f32 v75, v75
    v_smfmac_f32_32x32x32_bf16 v[128:143], v[180:183], v[64:71], v13
    s_waitcnt vmcnt(9)
    v_exp_f32 v76, v76
    v_exp_f32 v77, v77
    v_exp_f32 v78, v78
    v_exp_f32 v79, v79
    v_mfma_f32_32x32x8_bf16 v[32:47], v[204:205], v[240:241], 0
    v_exp_f32 v80, v80
    v_exp_f32 v81, v81
    v_exp_f32 v82, v82
    v_exp_f32 v83, v83
    v_mfma_f32_32x32x16_bf16 v[32:47], v[192:195], v[224:227], v[32:47]
    v_exp_f32 v84, v84
    v_exp_f32 v85, v85
    v_exp_f32 v86, v86
    v_exp_f32 v87, v87
    v_smfmac_f32_32x32x32_bf16 v[128:143], v[184:187], v[72:79], v13
    s_mov_b64 exec, s[62:63]
    buffer_load_dwordx4 v[168:171], v5, s[20:23], s66 offen sc1
    s_mov_b64 exec, -1
    v_exp_f32 v88, v88
    v_exp_f32 v89, v89
    v_exp_f32 v90, v90
    v_exp_f32 v91, v91
    v_smfmac_f32_32x32x32_bf16 v[144:159], v[180:183], v[80:87], v13
    s_add_u32 s66, s66, 163840
    s_cmp_eq_u32 s66, s57
    s_cselect_b32 s66, s56, s66
    v_exp_f32 v92, v92
    v_exp_f32 v93, v93
    v_exp_f32 v94, v94
    v_exp_f32 v95, v95
    v_mfma_f32_32x32x8_bf16 v[48:63], v[204:205], v[242:243], 0
    v_exp_f32 v32, v32
    v_exp_f32 v33, v33
    v_exp_f32 v34, v34
    v_exp_f32 v35, v35
    v_mfma_f32_32x32x16_bf16 v[48:63], v[192:195], v[228:231], v[48:63]
    s_waitcnt vmcnt(8)
    v_exp_f32 v36, v36
    v_exp_f32 v37, v37
    v_exp_f32 v38, v38
    v_exp_f32 v39, v39
    v_smfmac_f32_32x32x32_bf16 v[144:159], v[184:187], v[88:95], v13
    buffer_load_dwordx4 v[176:179], v2, s[20:23], s66 offen sc1
    v_exp_f32 v40, v40
    v_exp_f32 v41, v41
    v_exp_f32 v42, v42
    v_exp_f32 v43, v43
    v_smfmac_f32_32x32x32_bf16 v[96:111], v[196:199], v[32:39], v13
    v_exp_f32 v44, v44
    v_exp_f32 v45, v45
    v_exp_f32 v46, v46
    v_exp_f32 v47, v47
    v_mfma_f32_32x32x8_bf16 v[64:79], v[204:205], v[244:245], 0
    v_exp_f32 v48, v48
    v_exp_f32 v49, v49
    v_exp_f32 v50, v50
    v_exp_f32 v51, v51
    v_mfma_f32_32x32x16_bf16 v[64:79], v[192:195], v[232:235], v[64:79]
    v_exp_f32 v52, v52
    v_exp_f32 v53, v53
    v_exp_f32 v54, v54
    v_exp_f32 v55, v55
    v_smfmac_f32_32x32x32_bf16 v[96:111], v[200:203], v[40:47], v13
    s_mov_b64 exec, s[60:61]
    buffer_load_dwordx2 v[188:189], v3, s[20:23], s66 offen sc1
    s_mov_b64 exec, -1
    v_exp_f32 v56, v56
    v_exp_f32 v57, v57
    v_exp_f32 v58, v58
    v_exp_f32 v59, v59
    v_smfmac_f32_32x32x32_bf16 v[112:127], v[196:199], v[48:55], v13
    s_sub_u32 s67, s67, 1
    v_exp_f32 v60, v60
    v_exp_f32 v61, v61
    v_exp_f32 v62, v62
    v_exp_f32 v63, v63
    v_mfma_f32_32x32x8_bf16 v[80:95], v[204:205], v[246:247], 0
    v_exp_f32 v64, v64
    v_exp_f32 v65, v65
    v_exp_f32 v66, v66
    v_exp_f32 v67, v67
    v_mfma_f32_32x32x16_bf16 v[80:95], v[192:195], v[236:239], v[80:95]
    v_exp_f32 v68, v68
    v_exp_f32 v69, v69
    v_exp_f32 v70, v70
    v_exp_f32 v71, v71
    v_smfmac_f32_32x32x32_bf16 v[112:127], v[200:203], v[56:63], v13
    s_mov_b64 exec, s[62:63]
    buffer_load_dwordx4 v[180:183], v4, s[20:23], s66 offen sc1
    s_mov_b64 exec, -1
    v_exp_f32 v72, v72
    v_exp_f32 v73, v73
    v_exp_f32 v74, v74
    v_exp_f32 v75, v75
    v_smfmac_f32_32x32x32_bf16 v[128:143], v[196:199], v[64:71], v13
    s_waitcnt vmcnt(9)
    v_exp_f32 v76, v76
    v_exp_f32 v77, v77
    v_exp_f32 v78, v78
    v_exp_f32 v79, v79
    v_mfma_f32_32x32x8_bf16 v[32:47], v[220:221], v[240:241], 0
    v_exp_f32 v80, v80
    v_exp_f32 v81, v81
    v_exp_f32 v82, v82
    v_exp_f32 v83, v83
    v_mfma_f32_32x32x16_bf16 v[32:47], v[208:211], v[224:227], v[32:47]
    v_exp_f32 v84, v84
    v_exp_f32 v85, v85
    v_exp_f32 v86, v86
    v_exp_f32 v87, v87
    v_smfmac_f32_32x32x32_bf16 v[128:143], v[200:203], v[72:79], v13
    s_mov_b64 exec, s[62:63]
    buffer_load_dwordx4 v[184:187], v5, s[20:23], s66 offen sc1
    s_mov_b64 exec, -1
    v_exp_f32 v88, v88
    v_exp_f32 v89, v89
    v_exp_f32 v90, v90
    v_exp_f32 v91, v91
    v_smfmac_f32_32x32x32_bf16 v[144:159], v[196:199], v[80:87], v13
    s_add_u32 s66, s66, 163840
    s_cmp_eq_u32 s66, s57
    s_cselect_b32 s66, s56, s66
    v_exp_f32 v92, v92
    v_exp_f32 v93, v93
    v_exp_f32 v94, v94
    v_exp_f32 v95, v95
    v_mfma_f32_32x32x8_bf16 v[48:63], v[220:221], v[242:243], 0
    v_exp_f32 v32, v32
    v_exp_f32 v33, v33
    v_exp_f32 v34, v34
    v_exp_f32 v35, v35
    v_mfma_f32_32x32x16_bf16 v[48:63], v[208:211], v[228:231], v[48:63]
    s_waitcnt vmcnt(8)
    v_exp_f32 v36, v36
    v_exp_f32 v37, v37
    v_exp_f32 v38, v38
    v_exp_f32 v39, v39
    v_smfmac_f32_32x32x32_bf16 v[144:159], v[200:203], v[88:95], v13
    buffer_load_dwordx4 v[192:195], v2, s[20:23], s66 offen sc1
    v_exp_f32 v40, v40
    v_exp_f32 v41, v41
    v_exp_f32 v42, v42
    v_exp_f32 v43, v43
    v_smfmac_f32_32x32x32_bf16 v[96:111], v[212:215], v[32:39], v13
    v_exp_f32 v44, v44
    v_exp_f32 v45, v45
    v_exp_f32 v46, v46
    v_exp_f32 v47, v47
    v_mfma_f32_32x32x8_bf16 v[64:79], v[220:221], v[244:245], 0
    v_exp_f32 v48, v48
    v_exp_f32 v49, v49
    v_exp_f32 v50, v50
    v_exp_f32 v51, v51
    v_mfma_f32_32x32x16_bf16 v[64:79], v[208:211], v[232:235], v[64:79]
    v_exp_f32 v52, v52
    v_exp_f32 v53, v53
    v_exp_f32 v54, v54
    v_exp_f32 v55, v55
    v_smfmac_f32_32x32x32_bf16 v[96:111], v[216:219], v[40:47], v13
    s_mov_b64 exec, s[60:61]
    buffer_load_dwordx2 v[204:205], v3, s[20:23], s66 offen sc1
    s_mov_b64 exec, -1
    v_exp_f32 v56, v56
    v_exp_f32 v57, v57
    v_exp_f32 v58, v58
    v_exp_f32 v59, v59
    v_smfmac_f32_32x32x32_bf16 v[112:127], v[212:215], v[48:55], v13
    v_exp_f32 v60, v60
    v_exp_f32 v61, v61
    v_exp_f32 v62, v62
    v_exp_f32 v63, v63
    v_mfma_f32_32x32x8_bf16 v[80:95], v[220:221], v[246:247], 0
    v_exp_f32 v64, v64
    v_exp_f32 v65, v65
    v_exp_f32 v66, v66
    v_exp_f32 v67, v67
    v_mfma_f32_32x32x16_bf16 v[80:95], v[208:211], v[236:239], v[80:95]
    v_exp_f32 v68, v68
    v_exp_f32 v69, v69
    v_exp_f32 v70, v70
    v_exp_f32 v71, v71
    v_smfmac_f32_32x32x32_bf16 v[112:127], v[216:219], v[56:63], v13
    s_mov_b64 exec, s[62:63]
    buffer_load_dwordx4 v[196:199], v4, s[20:23], s66 offen sc1
    s_mov_b64 exec, -1
    v_exp_f32 v72, v72
    v_exp_f32 v73, v73
    v_exp_f32 v74, v74
    v_exp_f32 v75, v75
    v_smfmac_f32_32x32x32_bf16 v[128:143], v[212:215], v[64:71], v13
    s_waitcnt vmcnt(9)
    v_exp_f32 v76, v76
    v_exp_f32 v77, v77
    v_exp_f32 v78, v78
    v_exp_f32 v79, v79
    v_mfma_f32_32x32x8_bf16 v[32:47], v[172:173], v[240:241], 0
    v_exp_f32 v80, v80
    v_exp_f32 v81, v81
    v_exp_f32 v82, v82
    v_exp_f32 v83, v83
    v_mfma_f32_32x32x16_bf16 v[32:47], v[160:163], v[224:227], v[32:47]
    v_exp_f32 v84, v84
    v_exp_f32 v85, v85
    v_exp_f32 v86, v86
    v_exp_f32 v87, v87
    v_smfmac_f32_32x32x32_bf16 v[128:143], v[216:219], v[72:79], v13
    s_mov_b64 exec, s[62:63]
    buffer_load_dwordx4 v[200:203], v5, s[20:23], s66 offen sc1
    s_mov_b64 exec, -1
    v_exp_f32 v88, v88
    v_exp_f32 v89, v89
    v_exp_f32 v90, v90
    v_exp_f32 v91, v91
    v_smfmac_f32_32x32x32_bf16 v[144:159], v[212:215], v[80:87], v13
    s_add_u32 s66, s66, 163840
    s_cmp_eq_u32 s66, s57
    s_cselect_b32 s66, s56, s66
    v_exp_f32 v92, v92
    v_exp_f32 v93, v93
    v_exp_f32 v94, v94
    v_exp_f32 v95, v95
    s_cmp_lg_u32 s67, 0
    s_cbranch_scc1 L_loop
    v_smfmac_f32_32x32x32_bf16 v[144:159], v[216:219], v[88:95], v13
    s_setprio 3
    s_mul_i32 s41, s26, 20
    s_add_u32 s41, s41, 156932
    v_mov_b32 v253, s41
    s_cmp_eq_u32 s26, 0
    s_cselect_b32 s41, 20, 1
    s_mov_b32 s68, 0x2000000
L_lw_67:
    ds_read_b32 v255, v253
    s_sub_u32 s68, s68, 1
    s_cbranch_scc1 L_lwd_68
    s_waitcnt lgkmcnt(0)
    v_readfirstlane_b32 s40, v255
    s_cmp_ge_u32 s40, s41
    s_cbranch_scc1 L_lwd_68
    s_sleep 1
    s_branch L_lw_67
L_lwd_68:
    s_waitcnt lgkmcnt(0)
    ds_write_b128 v6, v[96:99] offset:0
    ds_write_b128 v6, v[100:103] offset:1024
    ds_write_b128 v6, v[104:107] offset:2048
    ds_write_b128 v7, v[112:115] offset:3072
    ds_write_b128 v7, v[116:119] offset:4096
    ds_write_b128 v7, v[120:123] offset:5120
    ds_write_b128 v8, v[128:131] offset:6144
    ds_write_b128 v8, v[132:135] offset:7168
    ds_write_b128 v8, v[136:139] offset:8192
    s_sub_u32 s40, s26, s65
    s_cmp_eq_u32 s40, 1
    s_cbranch_scc0 L_rs1
    s_waitcnt lgkmcnt(0)
    s_barrier
    s_branch L_rs2
L_rs1:
    v_mov_b32 v255, 1
    s_add_u32 s64, s64, 4
    s_waitcnt lgkmcnt(0)
    s_mov_b64 exec, 1
    ds_add_rtn_u32 v255, v12, v255
    s_mov_b64 exec, -1
    s_waitcnt lgkmcnt(0)
    v_readfirstlane_b32 s40, v255
    s_add_u32 s40, s40, 1
    s_cmp_ge_u32 s40, s64
    s_cbranch_scc1 L_gs_69
    s_mov_b32 s68, 0x2000000
L_lw_70:
    ds_read_b32 v255, v12
    s_sub_u32 s68, s68, 1
    s_cbranch_scc1 L_lwd_71
    s_waitcnt lgkmcnt(0)
    v_readfirstlane_b32 s40, v255
    s_cmp_ge_u32 s40, s64
    s_cbranch_scc1 L_lwd_71
    s_sleep 0
    s_branch L_lw_70
L_lwd_71:
    s_waitcnt lgkmcnt(0)
L_gs_69:
L_rs2:
    ds_read_b128 v[40:43], v9 offset:2048
    ds_read_b128 v[56:59], v9 offset:5120
    ds_read_b128 v[72:75], v9 offset:8192
    ds_read_b128 v[32:35], v9 offset:0
    ds_read_b128 v[48:51], v9 offset:3072
    ds_read_b128 v[64:67], v9 offset:6144
    ds_read_b128 v[36:39], v9 offset:1024
    ds_read_b128 v[52:55], v9 offset:4096
    ds_read_b128 v[68:71], v9 offset:7168
    s_waitcnt lgkmcnt(6)
    v_pk_add_f32 v[152:153], v[152:153], v[40:41]
    v_pk_add_f32 v[154:155], v[154:155], v[42:43]
    v_pk_add_f32 v[152:153], v[152:153], v[56:57]
    v_pk_add_f32 v[154:155], v[154:155], v[58:59]
    v_pk_add_f32 v[152:153], v[152:153], v[72:73]
    v_pk_add_f32 v[154:155], v[154:155], v[74:75]
    v_mov_b32 v21, v152
    v_mov_b32 v22, v152
    s_waitcnt lgkmcnt(3)
    v_mov_b32 v25, 0
    v_permlane32_swap_b32 v21, v22
    v_pk_add_f32 v[144:145], v[144:145], v[32:33]
    v_pk_add_f32 v[146:147], v[146:147], v[34:35]
    v_pk_add_f32 v[144:145], v[144:145], v[48:49]
    v_pk_add_f32 v[146:147], v[146:147], v[50:51]
    v_pk_add_f32 v[144:145], v[144:145], v[64:65]
    v_pk_add_f32 v[146:147], v[146:147], v[66:67]
    v_rcp_f32 v24, v22
    s_waitcnt lgkmcnt(0)
    v_pk_add_f32 v[148:149], v[148:149], v[36:37]
    v_pk_add_f32 v[150:151], v[150:151], v[38:39]
    v_pk_add_f32 v[148:149], v[148:149], v[52:53]
    v_pk_add_f32 v[150:151], v[150:151], v[54:55]
    v_pk_add_f32 v[148:149], v[148:149], v[68:69]
    v_pk_add_f32 v[150:151], v[150:151], v[70:71]
    v_pk_mul_f32 v[144:145], v[144:145], v[24:25] op_sel_hi:[1,0]
    v_pk_mul_f32 v[146:147], v[146:147], v[24:25] op_sel_hi:[1,0]
    v_pk_mul_f32 v[148:149], v[148:149], v[24:25] op_sel_hi:[1,0]
    v_pk_mul_f32 v[150:151], v[150:151], v[24:25] op_sel_hi:[1,0]
    v_pk_mul_f32 v[152:153], v[152:153], v[24:25] op_sel_hi:[1,0]
    v_pk_mul_f32 v[154:155], v[154:155], v[24:25] op_sel_hi:[1,0]
    v_subrev_u32 v21, 0x21800000, v22
    s_mov_b32 s46, 0x5a000000
    v_cmp_le_u32 s[44:45], s46, v21
    v_mov_b32 v24, 0
    v_pk_fma_f32 v[24:25], v[144:145], 0, v[24:25] op_sel_hi:[1,0,1]
    v_cvt_pk_bf16_f32 v26, v144, v145
    v_pk_fma_f32 v[24:25], v[146:147], 0, v[24:25] op_sel_hi:[1,0,1]
    v_cvt_pk_bf16_f32 v27, v146, v147
    v_pk_fma_f32 v[24:25], v[148:149], 0, v[24:25] op_sel_hi:[1,0,1]
    v_cvt_pk_bf16_f32 v28, v148, v149
    v_pk_fma_f32 v[24:25], v[150:151], 0, v[24:25] op_sel_hi:[1,0,1]
    v_cvt_pk_bf16_f32 v29, v150, v151
    v_pk_fma_f32 v[24:25], v[152:153], 0, v[24:25] op_sel_hi:[1,0,1]
    v_cvt_pk_bf16_f32 v30, v152, v153
    v_pk_fma_f32 v[24:25], v[154:155], 0, v[24:25] op_sel_hi:[1,0,1]
    v_cvt_pk_bf16_f32 v31, v154, v155
    v_add_f32 v24, v24, v25
    v_min_u32 v26, -2, v26
    v_min_u32 v27, -2, v27
    v_min_u32 v28, -2, v28
    v_min_u32 v29, -2, v29
    v_min_u32 v30, -2, v30
    v_min_u32 v31, -2, v31
    v_cmp_neq_f32 vcc, 0, v24
    s_or_b64 vcc, vcc, s[44:45]
    s_cbranch_vccz L_safe
    s_cmp_lg_u32 s65, 0
    s_cbranch_scc1 L_safe
    v_add_u32 v253, 8, v12
    v_mov_b32 v255, 1
    s_waitcnt lgkmcnt(0)
    s_mov_b64 exec, 1
    ds_add_u32 v253, v255
    s_mov_b64 exec, -1
    s_branch L_nost
L_safe:
    s_cmp_lg_u32 s59, 0
    s_cbranch_scc1 L_nost
    s_mov_b32 s59, 1
    s_waitcnt vmcnt(0)
    buffer_store_dwordx4 v[26:29], v14, s[12:15], s52 offen sc1
    s_mov_b64 exec, s[60:61]
    buffer_store_dwordx2 v[30:31], v15, s[12:15], s53 offen sc1
    s_mov_b64 exec, -1
    s_branch L_std
L_nost:
    s_waitcnt vmcnt(0)
L_std:
    s_cmp_lg_u32 s26, 0
    s_cbranch_scc1 L_nopz
    v_mov_b32 v32, -1
    v_mov_b32 v33, -1
    v_mov_b32 v34, -1
    v_mov_b32 v35, -1
    s_add_u32 s40, s52, 8192
    buffer_store_dwordx4 v[32:35], v14, s[12:15], s40 offen sc1
    s_mov_b64 exec, s[60:61]
    buffer_store_dwordx2 v[32:33], v15, s[12:15], s53 offen offset:2048 sc1
    s_mov_b64 exec, -1
    s_waitcnt vmcnt(0)
L_nopz:
    v_mov_b32 v255, 1
    s_add_u32 s64, s64, 4
    s_waitcnt lgkmcnt(0)
    s_mov_b64 exec, 1
    ds_add_rtn_u32 v255, v12, v255
    s_mov_b64 exec, -1
    s_waitcnt lgkmcnt(0)
    v_readfirstlane_b32 s40, v255
    s_add_u32 s40, s40, 1
    s_cmp_ge_u32 s40, s64
    s_cbranch_scc1 L_gs_72
    s_mov_b32 s68, 0x2000000
L_lw_73:
    ds_read_b32 v255, v12
    s_sub_u32 s68, s68, 1
    s_cbranch_scc1 L_lwd_74
    s_waitcnt lgkmcnt(0)
    v_readfirstlane_b32 s40, v255
    s_cmp_ge_u32 s40, s64
    s_cbranch_scc1 L_lwd_74
    s_sleep 0
    s_branch L_lw_73
L_lwd_74:
    s_waitcnt lgkmcnt(0)
L_gs_72:
    s_cmp_lg_u32 s65, 0
    s_cbranch_scc1 L_pub2
    ds_read_b32 v255, v12 offset:8
    s_waitcnt lgkmcnt(0)
    v_readfirstlane_b32 s40, v255
    s_cmp_eq_u32 s40, 0
    s_cbranch_scc1 L_pub2
    s_mov_b32 s65, 1
    s_mov_b32 s67, 16
    s_not_b64 exec, s[60:61]
    v_mov_b32 v240, 0
    v_mov_b32 v241, 0
    v_mov_b32 v242, 0
    v_mov_b32 v243, 0
    v_mov_b32 v244, 0
    v_mov_b32 v245, 0
    v_mov_b32 v246, 0
    v_mov_b32 v247, 0
    s_mov_b64 exec, -1
    v_mov_b32 v22, 0xff800000
    v_mov_b32 v23, 0xff800000
    v_mov_b32 v24, 0xff800000
    v_mov_b32 v25, 0xff800000
    s_mov_b32 s20, s12
    s_mov_b32 s21, s13
    s_mov_b32 s22, 0x10000000
L_fb:
    buffer_load_dwordx4 v[160:163], v2, s[20:23], s66 offen sc1
    s_mov_b64 exec, s[60:61]
    buffer_load_dwordx2 v[172:173], v3, s[20:23], s66 offen sc1
    s_mov_b64 exec, -1
    s_add_u32 s66, s66, 163840
    s_cmp_eq_u32 s66, s57
    s_cselect_b32 s66, s56, s66
    s_waitcnt vmcnt(0)
    v_mfma_f32_32x32x8_bf16 v[32:47], v[172:173], v[240:241], 0
    v_mfma_f32_32x32x16_bf16 v[32:47], v[160:163], v[224:227], v[32:47]
    v_mfma_f32_32x32x8_bf16 v[48:63], v[172:173], v[242:243], 0
    v_mfma_f32_32x32x16_bf16 v[48:63], v[160:163], v[228:231], v[48:63]
    v_mfma_f32_32x32x8_bf16 v[64:79], v[172:173], v[244:245], 0
    v_mfma_f32_32x32x16_bf16 v[64:79], v[160:163], v[232:235], v[64:79]
    v_mfma_f32_32x32x8_bf16 v[80:95], v[172:173], v[246:247], 0
    v_mfma_f32_32x32x16_bf16 v[80:95], v[160:163], v[236:239], v[80:95]
    s_nop 11
    v_max3_f32 v22, v32, v33, v22
    v_max3_f32 v22, v34, v35, v22
    v_max3_f32 v22, v36, v37, v22
    v_max3_f32 v22, v38, v39, v22
    v_max3_f32 v22, v40, v41, v22
    v_max3_f32 v22, v42, v43, v22
    v_max3_f32 v22, v44, v45, v22
    v_max3_f32 v22, v46, v47, v22
    v_max3_f32 v23, v48, v49, v23
    v_max3_f32 v23, v50, v51, v23
    v_max3_f32 v23, v52, v53, v23
    v_max3_f32 v23, v54, v55, v23
    v_max3_f32 v23, v56, v57, v23
    v_max3_f32 v23, v58, v59, v23
    v_max3_f32 v23, v60, v61, v23
    v_max3_f32 v23, v62, v63, v23
    v_max3_f32 v24, v64, v65, v24
    v_max3_f32 v24, v66, v67, v24
    v_max3_f32 v24, v68, v69, v24
    v_max3_f32 v24, v70, v71, v24
    v_max3_f32 v24, v72, v73, v24
    v_max3_f32 v24, v74, v75, v24
    v_max3_f32 v24, v76, v77, v24
    v_max3_f32 v24, v78, v79, v24
    v_max3_f32 v25, v80, v81, v25
    v_max3_f32 v25, v82, v83, v25
    v_max3_f32 v25, v84, v85, v25
    v_max3_f32 v25, v86, v87, v25
    v_max3_f32 v25, v88, v89, v25
    v_max3_f32 v25, v90, v91, v25
    v_max3_f32 v25, v92, v93, v25
    v_max3_f32 v25, v94, v95, v25
    s_sub_u32 s67, s67, 1
    s_cmp_lg_u32 s67, 0
    s_cbranch_scc1 L_fb
    v_lshlrev_b32 v16, 2, v10
    v_add_u32 v16, 103680, v16
    v_mov_b32 v26, v22
    s_nop 1
    v_permlane32_swap_b32 v22, v26
    s_nop 1
    v_max_f32 v22, v22, v26
    s_add_u32 s41, s25, 1
    s_and_b32 s41, s41, 3
    s_lshl_b32 s41, s41, 9
    v_add_u32 v17, s41, v16
    s_lshl_b32 s41, s25, 7
    v_add_u32 v26, s41, v17
    ds_write_b32 v26, v22
    v_mov_b32 v26, v23
    s_nop 1
    v_permlane32_swap_b32 v23, v26
    s_nop 1
    v_max_f32 v23, v23, v26
    s_add_u32 s41, s25, 2
    s_and_b32 s41, s41, 3
    s_lshl_b32 s41, s41, 9
    v_add_u32 v18, s41, v16
    s_lshl_b32 s41, s25, 7
    v_add_u32 v26, s41, v18
    ds_write_b32 v26, v23
    v_mov_b32 v26, v24
    s_nop 1
    v_permlane32_swap_b32 v24, v26
    s_nop 1
    v_max_f32 v24, v24, v26
    s_add_u32 s41, s25, 3
    s_and_b32 s41, s41, 3
    s_lshl_b32 s41, s41, 9
    v_add_u32 v19, s41, v16
    s_lshl_b32 s41, s25, 7
    v_add_u32 v26, s41, v19
    ds_write_b32 v26, v24
    v_mov_b32 v26, v25
    s_nop 1
    v_permlane32_swap_b32 v25, v26
    s_nop 1
    v_max_f32 v25, v25, v26
    s_add_u32 s41, s25, 4
    s_and_b32 s41, s41, 3
    s_lshl_b32 s41, s41, 9
    v_add_u32 v20, s41, v16
    s_lshl_b32 s41, s25, 7
    v_add_u32 v26, s41, v20
    ds_write_b32 v26, v25
    v_mov_b32 v255, 1
    s_add_u32 s64, s64, 4
    s_waitcnt lgkmcnt(0)
    s_mov_b64 exec, 1
    ds_add_rtn_u32 v255, v12, v255
    s_mov_b64 exec, -1
    s_waitcnt lgkmcnt(0)
    v_readfirstlane_b32 s40, v255
    s_add_u32 s40, s40, 1
    s_cmp_ge_u32 s40, s64
    s_cbranch_scc1 L_gs_75
    s_mov_b32 s68, 0x2000000
L_lw_76:
    ds_read_b32 v255, v12
    s_sub_u32 s68, s68, 1
    s_cbranch_scc1 L_lwd_77
    s_waitcnt lgkmcnt(0)
    v_readfirstlane_b32 s40, v255
    s_cmp_ge_u32 s40, s64
    s_cbranch_scc1 L_lwd_77
    s_sleep 0
    s_branch L_lw_76
L_lwd_77:
    s_waitcnt lgkmcnt(0)
L_gs_75:
    ds_read_b32 v26, v17 offset:0
    ds_read_b32 v27, v17 offset:128
    ds_read_b32 v28, v17 offset:256
    ds_read_b32 v29, v17 offset:384
    s_waitcnt lgkmcnt(0)
    v_max3_f32 v26, v26, v27, v28
    v_max_f32 v26, v26, v29
    v_cvt_pk_bf16_f32 v28, -v26, -v26
    v_lshlrev_b32 v27, 16, v28
    v_add_f32 v27, v26, v27
    v_cvt_pk_bf16_f32 v28, -v26, -v27
    v_and_b32 v29, 0xffff0000, v28
    v_add_f32 v27, v27, v29
    v_cvt_pk_bf16_f32 v29, -v27, 0
    s_not_b64 exec, s[60:61]
    v_mov_b32 v240, v28
    v_mov_b32 v241, v29
    s_mov_b64 exec, -1
    ds_read_b32 v26, v18 offset:0
    ds_read_b32 v27, v18 offset:128
    ds_read_b32 v28, v18 offset:256
    ds_read_b32 v29, v18 offset:384
    s_waitcnt lgkmcnt(0)
    v_max3_f32 v26, v26, v27, v28
    v_max_f32 v26, v26, v29
    v_cvt_pk_bf16_f32 v28, -v26, -v26
    v_lshlrev_b32 v27, 16, v28
    v_add_f32 v27, v26, v27
    v_cvt_pk_bf16_f32 v28, -v26, -v27
    v_and_b32 v29, 0xffff0000, v28
    v_add_f32 v27, v27, v29
    v_cvt_pk_bf16_f32 v29, -v27, 0
    s_not_b64 exec, s[60:61]
    v_mov_b32 v242, v28
    v_mov_b32 v243, v29
    s_mov_b64 exec, -1
    ds_read_b32 v26, v19 offset:0
    ds_read_b32 v27, v19 offset:128
    ds_read_b32 v28, v19 offset:256
    ds_read_b32 v29, v19 offset:384
    s_waitcnt lgkmcnt(0)
    v_max3_f32 v26, v26, v27, v28
    v_max_f32 v26, v26, v29
    v_cvt_pk_bf16_f32 v28, -v26, -v26
    v_lshlrev_b32 v27, 16, v28
    v_add_f32 v27, v26, v27
    v_cvt_pk_bf16_f32 v28, -v26, -v27
    v_and_b32 v29, 0xffff0000, v28
    v_add_f32 v27, v27, v29
    v_cvt_pk_bf16_f32 v29, -v27, 0
    s_not_b64 exec, s[60:61]
    v_mov_b32 v244, v28
    v_mov_b32 v245, v29
    s_mov_b64 exec, -1
    ds_read_b32 v26, v20 offset:0
    ds_read_b32 v27, v20 offset:128
    ds_read_b32 v28, v20 offset:256
    ds_read_b32 v29, v20 offset:384
    s_waitcnt lgkmcnt(0)
    v_max3_f32 v26, v26, v27, v28
    v_max_f32 v26, v26, v29
    v_cvt_pk_bf16_f32 v28, -v26, -v26
    v_lshlrev_b32 v27, 16, v28
    v_add_f32 v27, v26, v27
    v_cvt_pk_bf16_f32 v28, -v26, -v27
    v_and_b32 v29, 0xffff0000, v28
    v_add_f32 v27, v27, v29
    v_cvt_pk_bf16_f32 v29, -v27, 0
    s_not_b64 exec, s[60:61]
    v_mov_b32 v246, v28
    v_mov_b32 v247, v29
    s_mov_b64 exec, -1
    v_mov_b32 v255, 1
    s_add_u32 s64, s64, 4
    s_waitcnt lgkmcnt(0)
    s_mov_b64 exec, 1
    ds_add_rtn_u32 v255, v12, v255
    s_mov_b64 exec, -1
    s_waitcnt lgkmcnt(0)
    v_readfirstlane_b32 s40, v255
    s_add_u32 s40, s40, 1
    s_cmp_ge_u32 s40, s64
    s_cbranch_scc1 L_gs_78
    s_mov_b32 s68, 0x2000000
L_lw_79:
    ds_read_b32 v255, v12
    s_sub_u32 s68, s68, 1
    s_cbranch_scc1 L_lwd_80
    s_waitcnt lgkmcnt(0)
    v_readfirstlane_b32 s40, v255
    s_cmp_ge_u32 s40, s64
    s_cbranch_scc1 L_lwd_80
    s_sleep 0
    s_branch L_lw_79
L_lwd_80:
    s_waitcnt lgkmcnt(0)
L_gs_78:
    s_mul_i32 s66, s31, 163840
    s_add_u32 s66, s66, s56
    buffer_load_dwordx4 v[160:163], v2, s[20:23], s66 offen sc1
    s_mov_b64 exec, s[60:61]
    buffer_load_dwordx2 v[172:173], v3, s[20:23], s66 offen sc1
    s_mov_b64 exec, -1
    s_mov_b64 exec, s[62:63]
    buffer_load_dwordx4 v[164:167], v4, s[20:23], s66 offen sc1
    s_mov_b64 exec, -1
    s_mov_b64 exec, s[62:63]
    buffer_load_dwordx4 v[168:171], v5, s[20:23], s66 offen sc1
    s_mov_b64 exec, -1
    s_add_u32 s66, s66, 163840
    s_cmp_eq_u32 s66, s57
    s_cselect_b32 s66, s56, s66
    buffer_load_dwordx4 v[176:179], v2, s[20:23], s66 offen sc1
    s_mov_b64 exec, s[60:61]
    buffer_load_dwordx2 v[188:189], v3, s[20:23], s66 offen sc1
    s_mov_b64 exec, -1
    s_mov_b64 exec, s[62:63]
    buffer_load_dwordx4 v[180:183], v4, s[20:23], s66 offen sc1
    s_mov_b64 exec, -1
    s_mov_b64 exec, s[62:63]
    buffer_load_dwordx4 v[184:187], v5, s[20:23], s66 offen sc1
    s_mov_b64 exec, -1
    s_add_u32 s66, s66, 163840
    s_cmp_eq_u32 s66, s57
    s_cselect_b32 s66, s56, s66
    buffer_load_dwordx4 v[192:195], v2, s[20:23], s66 offen sc1
    s_mov_b64 exec, s[60:61]
    buffer_load_dwordx2 v[204:205], v3, s[20:23], s66 offen sc1
    s_mov_b64 exec, -1
    s_mov_b64 exec, s[62:63]
    buffer_load_dwordx4 v[196:199], v4, s[20:23], s66 offen sc1
    s_mov_b64 exec, -1
    s_mov_b64 exec, s[62:63]
    buffer_load_dwordx4 v[200:203], v5, s[20:23], s66 offen sc1
    s_mov_b64 exec, -1
    s_add_u32 s66, s66, 163840
    s_cmp_eq_u32 s66, s57
    s_cselect_b32 s66, s56, s66
    v_mov_b32 v96, 0
    v_mov_b32 v97, 0
    v_mov_b32 v98, 0
    v_mov_b32 v99, 0
    v_mov_b32 v100, 0
    v_mov_b32 v101, 0
    v_mov_b32 v102, 0
    v_mov_b32 v103, 0
    v_mov_b32 v104, 0
    v_mov_b32 v105, 0
    v_mov_b32 v106, 0
    v_mov_b32 v107, 0
    v_mov_b32 v108, 0
    v_mov_b32 v109, 0
    v_mov_b32 v110, 0
    v_mov_b32 v111, 0
    v_mov_b32 v112, 0
    v_mov_b32 v113, 0
    v_mov_b32 v114, 0
    v_mov_b32 v115, 0
    v_mov_b32 v116, 0
    v_mov_b32 v117, 0
    v_mov_b32 v118, 0
    v_mov_b32 v119, 0
    v_mov_b32 v120, 0
    v_mov_b32 v121, 0
    v_mov_b32 v122, 0
    v_mov_b32 v123, 0
    v_mov_b32 v124, 0
    v_mov_b32 v125, 0
    v_mov_b32 v126, 0
    v_mov_b32 v127, 0
    v_mov_b32 v128, 0
    v_mov_b32 v129, 0
    v_mov_b32 v130, 0
    v_mov_b32 v131, 0
    v_mov_b32 v132, 0
    v_mov_b32 v133, 0
    v_mov_b32 v134, 0
    v_mov_b32 v135, 0
    v_mov_b32 v136, 0
    v_mov_b32 v137, 0
    v_mov_b32 v138, 0
    v_mov_b32 v139, 0
    v_mov_b32 v140, 0
    v_mov_b32 v141, 0
    v_mov_b32 v142, 0
    v_mov_b32 v143, 0
    v_mov_b32 v144, 0
    v_mov_b32 v145, 0
    v_mov_b32 v146, 0
    v_mov_b32 v147, 0
    v_mov_b32 v148, 0
    v_mov_b32 v149, 0
    v_mov_b32 v150, 0
    v_mov_b32 v151, 0
    v_mov_b32 v152, 0
    v_mov_b32 v153, 0
    v_mov_b32 v154, 0
    v_mov_b32 v155, 0
    v_mov_b32 v156, 0
    v_mov_b32 v157, 0
    v_mov_b32 v158, 0
    v_mov_b32 v159, 0
    v_mov_b32 v88, 0
    v_mov_b32 v89, 0
    v_mov_b32 v90, 0
    v_mov_b32 v91, 0
    v_mov_b32 v92, 0
    v_mov_b32 v93, 0
    v_mov_b32 v94, 0
    v_mov_b32 v95, 0
    s_waitcnt vmcnt(8)
    s_branch L_main
L_pub2:
    s_cmp_lg_u32 s24, 0
    s_cbranch_scc1 L_pub2d
    s_lshl_b32 s41, s31, 11
    s_lshl_b32 s40, s32, 7
    s_add_u32 s40, s40, s41
    s_add_u32 s40, s40, 720896
    v_mov_b32 v255, s27
    v_mov_b32 v254, 0
    s_mov_b64 exec, 1
    buffer_store_dword v255, v254, s[12:15], s40 offen sc1
    s_mov_b64 exec, -1
    v_mov_b32 v254, 156952
    v_mov_b32 v255, 1
    s_waitcnt lgkmcnt(0)
    s_mov_b64 exec, 1
    ds_add_u32 v254, v255
    s_mov_b64 exec, -1
L_pub2d:
    v_lshlrev_b32 v4, 4, v1
    v_add_u32 v226, 160512, v4
    ds_read_b128 v[240:243], v226
    ds_read_b128 v[244:247], v226 offset:1024
    v_lshrrev_b32 v225, 4, v1
    v_and_b32 v224, 15, v1
    s_lshl_b32 s55, s33, 2
    s_add_u32 s55, s55, s25
    s_lshl_b32 s30, s55, 14
    s_add_u32 s30, s30, 11534336
    s_lshl_b32 s52, s55, 12
    s_add_u32 s52, s52, 13631488
    s_lshl_b32 s53, s55, 4
    s_lshr_b32 s54, s33, 1
    s_lshl_b32 s54, s54, 11
    s_add_u32 s54, s54, 720896
    s_mul_i32 s39, s53, 1280
    s_mul_i32 s40, s34, 160
    s_add_u32 s39, s39, s40
    s_waitcnt lgkmcnt(0)
    s_cmp_lg_u32 s26, 0
    s_cbranch_scc1 L_p3b
    s_setprio 2
    v_mov_b32 v254, 156932
    s_mov_b32 s68, 0x2000000
L_lw_81:
    ds_read_b32 v255, v254
    s_sub_u32 s68, s68, 1
    s_cbranch_scc1 L_lwd_82
    s_waitcnt lgkmcnt(0)
    v_readfirstlane_b32 s40, v255
    s_cmp_ge_u32 s40, 28
    s_cbranch_scc1 L_lwd_82
    s_sleep 8
    s_branch L_lw_81
L_lwd_82:
    s_waitcnt lgkmcnt(0)
    v_add_u32 v230, s53, v224
    v_lshlrev_b32 v231, 7, v224
    buffer_load_dwordx4 v[200:203], v243, s[4:7], s39 offen
    buffer_load_dwordx4 v[204:207], v243, s[4:7], s39 offen offset:16
    buffer_load_dwordx2 v[208:209], v243, s[4:7], s39 offen offset:32
    v_mov_b32 v233, 0
    v_lshlrev_b32 v232, 3, v230
    s_mov_b32 s40, 65536
    s_mov_b32 s41, 102400
    buffer_load_dwordx4 v[236:239], v233, s[12:15], s41 offen sc1
    buffer_load_dwordx2 v[210:211], v232, s[12:15], s40 offen sc1
    s_cmp_eq_u32 s25, 0
    s_cbranch_scc1 L_nowo3
    s_sub_u32 s55, s25, 1
    s_load_dwordx2 s[8:9], s[0:1], 16
    s_mov_b32 s10, 819200
    s_mul_i32 s40, s34, 160
    v_add_u32 v247, s40, v247
    s_add_u32 s40, s55, 0
    s_mul_i32 s43, s40, 960
    s_mul_i32 s69, s40, 7680
    s_and_b32 s41, s33, 3
    s_mul_i32 s41, s41, 27
    s_add_u32 s40, s40, s41
    s_mul_i32 s42, s40, 960
    s_mul_i32 s41, s40, 7680
    s_mov_b32 exec_hi, 0xfffffff
    s_waitcnt lgkmcnt(0)
    s_mov_b32 m0, s42
    s_add_u32 s42, s42, 2880
    buffer_load_dwordx4 v247, s[8:11], s41 offen lds
    s_add_u32 s41, s41, 23040
    s_waitcnt vmcnt(1)
    s_mov_b32 m0, s42
    s_add_u32 s42, s42, 2880
    buffer_load_dwordx4 v247, s[8:11], s41 offen lds
    s_add_u32 s41, s41, 23040
    s_waitcnt vmcnt(1)
    s_mov_b32 m0, s42
    s_add_u32 s42, s42, 2880
    buffer_load_dwordx4 v247, s[8:11], s41 offen lds
    s_add_u32 s41, s41, 23040
    s_waitcnt vmcnt(1)
    s_mov_b32 m0, s42
    s_add_u32 s42, s42, 2880
    buffer_load_dwordx4 v247, s[8:11], s41 offen lds
    s_add_u32 s41, s41, 23040
    s_waitcnt vmcnt(1)
    s_mov_b32 m0, s42
    s_add_u32 s42, s42, 2880
    buffer_load_dwordx4 v247, s[8:11], s41 offen lds
    s_add_u32 s41, s41, 23040
    s_waitcnt vmcnt(1)
    s_mov_b32 m0, s42
    s_add_u32 s42, s42, 2880
    buffer_load_dwordx4 v247, s[8:11], s41 offen lds
    s_add_u32 s41, s41, 23040
    s_waitcnt vmcnt(1)
    s_mov_b32 m0, s42
    s_add_u32 s42, s42, 2880
    buffer_load_dwordx4 v247, s[8:11], s41 offen lds
    s_add_u32 s41, s41, 23040
    s_waitcnt vmcnt(1)
    s_mov_b32 m0, s42
    s_add_u32 s42, s42, 2880
    buffer_load_dwordx4 v247, s[8:11], s41 offen lds
    s_add_u32 s41, s41, 23040
    s_waitcnt vmcnt(1)
    s_mov_b32 m0, s42
    s_add_u32 s42, s42, 2880
    buffer_load_dwordx4 v247, s[8:11], s41 offen lds
    s_add_u32 s41, s41, 23040
    s_cmp_ge_u32 s42, 103680
    s_cselect_b32 s42, s43, s42
    s_cselect_b32 s41, s69, s41
    s_waitcnt vmcnt(1)
    s_mov_b32 m0, s42
    s_add_u32 s42, s42, 2880
    buffer_load_dwordx4 v247, s[8:11], s41 offen lds
    s_add_u32 s41, s41, 23040
    s_waitcnt vmcnt(1)
    s_mov_b32 m0, s42
    s_add_u32 s42, s42, 2880
    buffer_load_dwordx4 v247, s[8:11], s41 offen lds
    s_add_u32 s41, s41, 23040
    s_waitcnt vmcnt(1)
    s_mov_b32 m0, s42
    s_add_u32 s42, s42, 2880
    buffer_load_dwordx4 v247, s[8:11], s41 offen lds
    s_add_u32 s41, s41, 23040
    s_waitcnt vmcnt(1)
    s_mov_b32 m0, s42
    s_add_u32 s42, s42, 2880
    buffer_load_dwordx4 v247, s[8:11], s41 offen lds
    s_add_u32 s41, s41, 23040
    s_waitcnt vmcnt(1)
    s_mov_b32 m0, s42
    s_add_u32 s42, s42, 2880
    buffer_load_dwordx4 v247, s[8:11], s41 offen lds
    s_add_u32 s41, s41, 23040
    s_waitcnt vmcnt(1)
    s_mov_b32 m0, s42
    s_add_u32 s42, s42, 2880
    buffer_load_dwordx4 v247, s[8:11], s41 offen lds
    s_add_u32 s41, s41, 23040
    s_waitcnt vmcnt(1)
    s_mov_b32 m0, s42
    s_add_u32 s42, s42, 2880
    buffer_load_dwordx4 v247, s[8:11], s41 offen lds
    s_add_u32 s41, s41, 23040
    s_waitcnt vmcnt(1)
    s_mov_b32 m0, s42
    s_add_u32 s42, s42, 2880
    buffer_load_dwordx4 v247, s[8:11], s41 offen lds
    s_add_u32 s41, s41, 23040
    s_waitcnt vmcnt(1)
    s_mov_b32 m0, s42
    s_add_u32 s42, s42, 2880
    buffer_load_dwordx4 v247, s[8:11], s41 offen lds
    s_add_u32 s41, s41, 23040
    s_cmp_ge_u32 s42, 103680
    s_cselect_b32 s42, s43, s42
    s_cselect_b32 s41, s69, s41
    s_waitcnt vmcnt(1)
    s_mov_b32 m0, s42
    s_add_u32 s42, s42, 2880
    buffer_load_dwordx4 v247, s[8:11], s41 offen lds
    s_add_u32 s41, s41, 23040
    s_waitcnt vmcnt(1)
    s_mov_b32 m0, s42
    s_add_u32 s42, s42, 2880
    buffer_load_dwordx4 v247, s[8:11], s41 offen lds
    s_add_u32 s41, s41, 23040
    s_waitcnt vmcnt(1)
    s_mov_b32 m0, s42
    s_add_u32 s42, s42, 2880
    buffer_load_dwordx4 v247, s[8:11], s41 offen lds
    s_add_u32 s41, s41, 23040
    s_waitcnt vmcnt(1)
    s_mov_b32 m0, s42
    s_add_u32 s42, s42, 2880
    buffer_load_dwordx4 v247, s[8:11], s41 offen lds
    s_add_u32 s41, s41, 23040
    s_waitcnt vmcnt(1)
    s_mov_b32 m0, s42
    s_add_u32 s42, s42, 2880
    buffer_load_dwordx4 v247, s[8:11], s41 offen lds
    s_add_u32 s41, s41, 23040
    s_waitcnt vmcnt(1)
    s_mov_b32 m0, s42
    s_add_u32 s42, s42, 2880
    buffer_load_dwordx4 v247, s[8:11], s41 offen lds
    s_add_u32 s41, s41, 23040
    s_waitcnt vmcnt(1)
    s_mov_b32 m0, s42
    s_add_u32 s42, s42, 2880
    buffer_load_dwordx4 v247, s[8:11], s41 offen lds
    s_add_u32 s41, s41, 23040
    s_waitcnt vmcnt(1)
    s_mov_b32 m0, s42
    s_add_u32 s42, s42, 2880
    buffer_load_dwordx4 v247, s[8:11], s41 offen lds
    s_add_u32 s41, s41, 23040
    s_waitcnt vmcnt(1)
    s_mov_b32 m0, s42
    s_add_u32 s42, s42, 2880
    buffer_load_dwordx4 v247, s[8:11], s41 offen lds
    s_add_u32 s41, s41, 23040
    s_cmp_ge_u32 s42, 103680
    s_cselect_b32 s42, s43, s42
    s_cselect_b32 s41, s69, s41
    s_waitcnt vmcnt(1)
    s_mov_b32 m0, s42
    s_add_u32 s42, s42, 2880
    buffer_load_dwordx4 v247, s[8:11], s41 offen lds
    s_add_u32 s41, s41, 23040
    s_waitcnt vmcnt(1)
    s_mov_b32 m0, s42
    s_add_u32 s42, s42, 2880
    buffer_load_dwordx4 v247, s[8:11], s41 offen lds
    s_add_u32 s41, s41, 23040
    s_waitcnt vmcnt(1)
    s_mov_b32 m0, s42
    s_add_u32 s42, s42, 2880
    buffer_load_dwordx4 v247, s[8:11], s41 offen lds
    s_add_u32 s41, s41, 23040
    s_waitcnt vmcnt(1)
    s_mov_b32 m0, s42
    s_add_u32 s42, s42, 2880
    buffer_load_dwordx4 v247, s[8:11], s41 offen lds
    s_add_u32 s41, s41, 23040
    s_waitcnt vmcnt(1)
    s_mov_b32 m0, s42
    s_add_u32 s42, s42, 2880
    buffer_load_dwordx4 v247, s[8:11], s41 offen lds
    s_add_u32 s41, s41, 23040
    s_waitcnt vmcnt(1)
    s_mov_b32 m0, s42
    s_add_u32 s42, s42, 2880
    buffer_load_dwordx4 v247, s[8:11], s41 offen lds
    s_add_u32 s41, s41, 23040
    s_waitcnt vmcnt(1)
    s_mov_b32 m0, s42
    s_add_u32 s42, s42, 2880
    buffer_load_dwordx4 v247, s[8:11], s41 offen lds
    s_add_u32 s41, s41, 23040
    s_waitcnt vmcnt(1)
    s_mov_b32 m0, s42
    s_add_u32 s42, s42, 2880
    buffer_load_dwordx4 v247, s[8:11], s41 offen lds
    s_add_u32 s41, s41, 23040
    s_waitcnt vmcnt(1)
    s_mov_b32 m0, s42
    s_add_u32 s42, s42, 2880
    buffer_load_dwordx4 v247, s[8:11], s41 offen lds
    s_add_u32 s41, s41, 23040
    s_waitcnt vmcnt(1)
    s_mov_b64 exec, -1
L_nowo3:
    s_mov_b32 s40, 65536
    s_waitcnt vmcnt(0)
    s_mov_b32 s68, 0x100000
    s_branch L_tgc_85
L_tg_83:
    buffer_load_dwordx2 v[210:211], v232, s[12:15], s40 offen sc1
    s_sub_u32 s68, s68, 1
    s_waitcnt vmcnt(0)
    s_cbranch_scc1 L_tgd_84
L_tgc_85:
    v_cmp_ne_u32 vcc, s27, v211
    s_cbranch_vccnz L_tg_83
L_tgd_84:
    v_readfirstlane_b32 s44, v236
    v_readfirstlane_b32 s46, v237
    v_readfirstlane_b32 s45, v238
    v_readfirstlane_b32 s47, v239
    v_and_b32 v234, 0xffff0000, v210
    v_rcp_f32 v234, v234
    v_lshlrev_b32 v235, 16, v210
    v_mul_f32 v235, v235, v234
    v_add_f32 v234, 1.0, v234
    v_lshlrev_b32 v8, 16, v200
    v_and_b32 v9, 0xffff0000, v200
    v_fma_f32 v8, v8, v234, -v235
    v_fma_f32 v9, v9, v234, -v235
    v_lshlrev_b32 v10, 16, v201
    v_and_b32 v11, 0xffff0000, v201
    v_fma_f32 v10, v10, v234, -v235
    v_fma_f32 v11, v11, v234, -v235
    v_lshlrev_b32 v12, 16, v202
    v_and_b32 v13, 0xffff0000, v202
    v_fma_f32 v12, v12, v234, -v235
    v_fma_f32 v13, v13, v234, -v235
    v_lshlrev_b32 v14, 16, v203
    v_and_b32 v15, 0xffff0000, v203
    v_fma_f32 v14, v14, v234, -v235
    v_fma_f32 v15, v15, v234, -v235
    v_lshlrev_b32 v16, 16, v204
    v_and_b32 v17, 0xffff0000, v204
    v_fma_f32 v16, v16, v234, -v235
    v_fma_f32 v17, v17, v234, -v235
    v_lshlrev_b32 v18, 16, v205
    v_and_b32 v19, 0xffff0000, v205
    v_fma_f32 v18, v18, v234, -v235
    v_fma_f32 v19, v19, v234, -v235
    v_lshlrev_b32 v20, 16, v206
    v_and_b32 v21, 0xffff0000, v206
    v_fma_f32 v20, v20, v234, -v235
    v_fma_f32 v21, v21, v234, -v235
    v_lshlrev_b32 v22, 16, v207
    v_and_b32 v23, 0xffff0000, v207
    v_fma_f32 v22, v22, v234, -v235
    v_fma_f32 v23, v23, v234, -v235
    v_lshlrev_b32 v24, 16, v208
    v_and_b32 v25, 0xffff0000, v208
    v_fma_f32 v24, v24, v234, -v235
    v_fma_f32 v25, v25, v234, -v235
    v_lshlrev_b32 v26, 16, v209
    v_and_b32 v27, 0xffff0000, v209
    v_fma_f32 v26, v26, v234, -v235
    v_fma_f32 v27, v27, v234, -v235
    s_cmp_lg_u32 s25, 0
    s_cbranch_scc1 L_nog
    s_sub_u32 s40, s44, s53
    s_sub_u32 s41, s45, s53
    s_min_u32 s40, s40, s41
    s_cmp_ge_u32 s40, 64
    s_cbranch_scc1 L_noy
    s_mul_i32 s40, s34, 80
    v_min_u32 v233, 39, v1
    v_lshl_add_u32 v232, v233, 1, s40
    s_lshr_b32 s41, s40, 6
    s_mul_i32 s41, s41, 24
    v_min_u32 v234, 47, v1
    v_add_lshl_u32 v234, v234, s41, 7
    s_mov_b32 s43, 851968
    v_lshrrev_b32 v235, 6, v232
    v_mul_u32_u24 v235, 12288, v235
    v_and_b32 v232, 63, v232
    v_lshl_add_u32 v232, v232, 3, v235
    s_mov_b32 s68, 0x100000
L_pl_86:
    buffer_load_dword v252, v234, s[12:15], s43 offen sc1
    s_sub_u32 s68, s68, 1
    s_waitcnt vmcnt(0)
    s_cbranch_scc1 L_pld_87
    v_cmp_ne_u32 vcc, s27, v252
    s_cbranch_vccz L_pld_87
    s_sleep 4
    s_branch L_pl_86
L_pld_87:
    s_mov_b32 s40, 393216
    buffer_load_dwordx4 v[96:99], v232, s[12:15], s40 offen offset:0 sc1
    buffer_load_dwordx4 v[100:103], v232, s[12:15], s40 offen offset:512 sc1
    buffer_load_dwordx4 v[104:107], v232, s[12:15], s40 offen offset:1024 sc1
    buffer_load_dwordx4 v[108:111], v232, s[12:15], s40 offen offset:1536 sc1
    buffer_load_dwordx4 v[112:115], v232, s[12:15], s40 offen offset:2048 sc1
    buffer_load_dwordx4 v[116:119], v232, s[12:15], s40 offen offset:2560 sc1
    buffer_load_dwordx4 v[120:123], v232, s[12:15], s40 offen offset:3072 sc1
    buffer_load_dwordx4 v[124:127], v232, s[12:15], s40 offen offset:3584 sc1
    s_add_u32 s40, s40, 4096
    buffer_load_dwordx4 v[128:131], v232, s[12:15], s40 offen offset:0 sc1
    buffer_load_dwordx4 v[132:135], v232, s[12:15], s40 offen offset:512 sc1
    buffer_load_dwordx4 v[136:139], v232, s[12:15], s40 offen offset:1024 sc1
    buffer_load_dwordx4 v[140:143], v232, s[12:15], s40 offen offset:1536 sc1
    buffer_load_dwordx4 v[144:147], v232, s[12:15], s40 offen offset:2048 sc1
    buffer_load_dwordx4 v[148:151], v232, s[12:15], s40 offen offset:2560 sc1
    buffer_load_dwordx4 v[152:155], v232, s[12:15], s40 offen offset:3072 sc1
    buffer_load_dwordx4 v[156:159], v232, s[12:15], s40 offen offset:3584 sc1
    s_add_u32 s40, s40, 4096
    buffer_load_dwordx4 v[160:163], v232, s[12:15], s40 offen offset:0 sc1
    buffer_load_dwordx4 v[164:167], v232, s[12:15], s40 offen offset:512 sc1
    buffer_load_dwordx4 v[168:171], v232, s[12:15], s40 offen offset:1024 sc1
    buffer_load_dwordx4 v[172:175], v232, s[12:15], s40 offen offset:1536 sc1
    buffer_load_dwordx4 v[176:179], v232, s[12:15], s40 offen offset:2048 sc1
    buffer_load_dwordx4 v[180:183], v232, s[12:15], s40 offen offset:2560 sc1
    buffer_load_dwordx4 v[184:187], v232, s[12:15], s40 offen offset:3072 sc1
    buffer_load_dwordx4 v[188:191], v232, s[12:15], s40 offen offset:3584 sc1
    s_add_u32 s40, s40, 4096
    s_mov_b32 s40, 159744
    v_lshl_add_u32 v234, v233, 3, s40
    v_mul_u32_u24 v235, 80, v225
    v_add_u32 v235, s40, v235
    s_waitcnt vmcnt(0)
    v_pk_add_f32 v[96:97], v[96:97], v[100:101]
    v_pk_add_f32 v[98:99], v[98:99], v[102:103]
    v_pk_add_f32 v[96:97], v[96:97], v[104:105]
    v_pk_add_f32 v[98:99], v[98:99], v[106:107]
    v_pk_add_f32 v[96:97], v[96:97], v[108:109]
    v_pk_add_f32 v[98:99], v[98:99], v[110:111]
    v_pk_add_f32 v[96:97], v[96:97], v[112:113]
    v_pk_add_f32 v[98:99], v[98:99], v[114:115]
    v_pk_add_f32 v[96:97], v[96:97], v[116:117]
    v_pk_add_f32 v[98:99], v[98:99], v[118:119]
    v_pk_add_f32 v[96:97], v[96:97], v[120:121]
    v_pk_add_f32 v[98:99], v[98:99], v[122:123]
    v_pk_add_f32 v[96:97], v[96:97], v[124:125]
    v_pk_add_f32 v[98:99], v[98:99], v[126:127]
    v_pk_add_f32 v[96:97], v[96:97], v[128:129]
    v_pk_add_f32 v[98:99], v[98:99], v[130:131]
    v_pk_add_f32 v[96:97], v[96:97], v[132:133]
    v_pk_add_f32 v[98:99], v[98:99], v[134:135]
    v_pk_add_f32 v[96:97], v[96:97], v[136:137]
    v_pk_add_f32 v[98:99], v[98:99], v[138:139]
    v_pk_add_f32 v[96:97], v[96:97], v[140:141]
    v_pk_add_f32 v[98:99], v[98:99], v[142:143]
    v_pk_add_f32 v[96:97], v[96:97], v[144:145]
    v_pk_add_f32 v[98:99], v[98:99], v[146:147]
    v_pk_add_f32 v[96:97], v[96:97], v[148:149]
    v_pk_add_f32 v[98:99], v[98:99], v[150:151]
    v_pk_add_f32 v[96:97], v[96:97], v[152:153]
    v_pk_add_f32 v[98:99], v[98:99], v[154:155]
    v_pk_add_f32 v[96:97], v[96:97], v[156:157]
    v_pk_add_f32 v[98:99], v[98:99], v[158:159]
    v_pk_add_f32 v[96:97], v[96:97], v[160:161]
    v_pk_add_f32 v[98:99], v[98:99], v[162:163]
    v_pk_add_f32 v[96:97], v[96:97], v[164:165]
    v_pk_add_f32 v[98:99], v[98:99], v[166:167]
    v_pk_add_f32 v[96:97], v[96:97], v[168:169]
    v_pk_add_f32 v[98:99], v[98:99], v[170:171]
    v_pk_add_f32 v[96:97], v[96:97], v[172:173]
    v_pk_add_f32 v[98:99], v[98:99], v[174:175]
    v_pk_add_f32 v[96:97], v[96:97], v[176:177]
    v_pk_add_f32 v[98:99], v[98:99], v[178:179]
    v_pk_add_f32 v[96:97], v[96:97], v[180:181]
    v_pk_add_f32 v[98:99], v[98:99], v[182:183]
    v_pk_add_f32 v[96:97], v[96:97], v[184:185]
    v_pk_add_f32 v[98:99], v[98:99], v[186:187]
    v_pk_add_f32 v[96:97], v[96:97], v[188:189]
    v_pk_add_f32 v[98:99], v[98:99], v[190:191]
    v_cvt_pk_bf16_f32 v96, v96, v96
    v_lshlrev_b32 v96, 16, v96
    v_mul_f32 v96, s46, v96
    v_cvt_pk_bf16_f32 v96, v96, v96
    v_lshlrev_b32 v96, 16, v96
    v_cvt_pk_bf16_f32 v97, v97, v97
    v_lshlrev_b32 v97, 16, v97
    v_mul_f32 v97, s47, v97
    v_cvt_pk_bf16_f32 v97, v97, v97
    v_lshlrev_b32 v97, 16, v97
    v_cvt_pk_bf16_f32 v98, v98, v98
    v_lshlrev_b32 v98, 16, v98
    v_mul_f32 v98, s46, v98
    v_cvt_pk_bf16_f32 v98, v98, v98
    v_lshlrev_b32 v98, 16, v98
    v_cvt_pk_bf16_f32 v99, v99, v99
    v_lshlrev_b32 v99, 16, v99
    v_mul_f32 v99, s47, v99
    v_cvt_pk_bf16_f32 v99, v99, v99
    v_lshlrev_b32 v99, 16, v99
    ds_write2_b32 v234, v96, v98 offset0:0 offset1:1
    ds_write2_b32 v234, v97, v99 offset0:96 offset1:97
    s_waitcnt lgkmcnt(0)
    v_mov_b32 v254, 156968
    v_mov_b32 v255, 1
    s_waitcnt lgkmcnt(0)
    s_mov_b64 exec, 1
    ds_add_u32 v254, v255
    s_mov_b64 exec, -1
L_nog:
    s_sub_u32 s40, s44, s53
    s_sub_u32 s48, s45, s53
    s_min_u32 s40, s40, s48
    s_cmp_ge_u32 s40, 16
    s_cbranch_scc1 L_noy_88
    v_mul_u32_u24 v235, 80, v225
    v_add_u32 v235, 159744, v235
    v_mov_b32 v254, 156968
    s_mov_b32 s68, 0x2000000
L_lw_89:
    ds_read_b32 v255, v254
    s_sub_u32 s68, s68, 1
    s_cbranch_scc1 L_lwd_90
    s_waitcnt lgkmcnt(0)
    v_readfirstlane_b32 s40, v255
    s_cmp_ge_u32 s40, 1
    s_cbranch_scc1 L_lwd_90
    s_sleep 2
    s_branch L_lw_89
L_lwd_90:
    s_waitcnt lgkmcnt(0)
    ds_read_b128 v[104:107], v235 offset:0
    ds_read_b128 v[108:111], v235 offset:16
    ds_read_b128 v[112:115], v235 offset:32
    ds_read_b128 v[116:119], v235 offset:48
    ds_read_b128 v[120:123], v235 offset:64
    v_cmp_eq_u32 vcc, s44, v230
    s_waitcnt lgkmcnt(0)
    s_and_saveexec_b64 s[48:49], vcc
    s_cbranch_execz L_ny_91
    v_pk_add_f32 v[8:9], v[8:9], v[104:105]
    v_pk_add_f32 v[10:11], v[10:11], v[106:107]
    v_pk_add_f32 v[12:13], v[12:13], v[108:109]
    v_pk_add_f32 v[14:15], v[14:15], v[110:111]
    v_pk_add_f32 v[16:17], v[16:17], v[112:113]
    v_pk_add_f32 v[18:19], v[18:19], v[114:115]
    v_pk_add_f32 v[20:21], v[20:21], v[116:117]
    v_pk_add_f32 v[22:23], v[22:23], v[118:119]
    v_pk_add_f32 v[24:25], v[24:25], v[120:121]
    v_pk_add_f32 v[26:27], v[26:27], v[122:123]
L_ny_91:
    s_mov_b64 exec, -1
    ds_read_b128 v[104:107], v235 offset:384
    ds_read_b128 v[108:111], v235 offset:400
    ds_read_b128 v[112:115], v235 offset:416
    ds_read_b128 v[116:119], v235 offset:432
    ds_read_b128 v[120:123], v235 offset:448
    v_cmp_eq_u32 vcc, s45, v230
    s_waitcnt lgkmcnt(0)
    s_and_saveexec_b64 s[48:49], vcc
    s_cbranch_execz L_ny_92
    v_pk_add_f32 v[8:9], v[8:9], v[104:105]
    v_pk_add_f32 v[10:11], v[10:11], v[106:107]
    v_pk_add_f32 v[12:13], v[12:13], v[108:109]
    v_pk_add_f32 v[14:15], v[14:15], v[110:111]
    v_pk_add_f32 v[16:17], v[16:17], v[112:113]
    v_pk_add_f32 v[18:19], v[18:19], v[114:115]
    v_pk_add_f32 v[20:21], v[20:21], v[116:117]
    v_pk_add_f32 v[22:23], v[22:23], v[118:119]
    v_pk_add_f32 v[24:25], v[24:25], v[120:121]
    v_pk_add_f32 v[26:27], v[26:27], v[122:123]
L_ny_92:
    s_mov_b64 exec, -1
L_noy_88:
L_noy:
    s_mov_b32 s68, 0x100000
L_pl_93:
    buffer_load_dword v252, v231, s[12:15], s54 offen sc1
    s_sub_u32 s68, s68, 1
    s_waitcnt vmcnt(0)
    s_cbranch_scc1 L_pld_94
    v_cmp_ne_u32 vcc, s27, v252
    s_cbranch_vccz L_pld_94
    s_sleep 8
    s_branch L_pl_93
L_pld_94:
    s_add_u32 s40, s30, 0
    buffer_load_dwordx4 v[32:35], v4, s[12:15], s40 offen offset:0 sc1
    s_add_u32 s40, s30, 0
    buffer_load_dwordx4 v[36:39], v4, s[12:15], s40 offen offset:1024 sc1
    s_add_u32 s40, s30, 0
    buffer_load_dwordx4 v[40:43], v4, s[12:15], s40 offen offset:2048 sc1
    s_add_u32 s40, s30, 0
    buffer_load_dwordx4 v[44:47], v4, s[12:15], s40 offen offset:3072 sc1
    s_add_u32 s40, s30, 4096
    buffer_load_dwordx4 v[48:51], v4, s[12:15], s40 offen offset:0 sc1
    s_add_u32 s40, s30, 4096
    buffer_load_dwordx4 v[52:55], v4, s[12:15], s40 offen offset:1024 sc1
    s_add_u32 s40, s30, 4096
    buffer_load_dwordx4 v[56:59], v4, s[12:15], s40 offen offset:2048 sc1
    s_add_u32 s40, s30, 4096
    buffer_load_dwordx4 v[60:63], v4, s[12:15], s40 offen offset:3072 sc1
    buffer_load_dwordx2 v[64:65], v242, s[12:15], s52 offen offset:0 sc1
    buffer_load_dwordx2 v[66:67], v242, s[12:15], s52 offen offset:128 sc1
    buffer_load_dwordx2 v[68:69], v242, s[12:15], s52 offen offset:1024 sc1
    buffer_load_dwordx2 v[70:71], v242, s[12:15], s52 offen offset:1152 sc1
L_ab0:
    s_setprio 2
    s_barrier
    s_mul_i32 s40, s25, 5376
    s_mul_i32 s41, s26, 103680
    s_add_u32 s41, s41, s40
    v_add_u32 v236, s41, v244
    s_mul_i32 s41, s26, 2688
    s_add_u32 s41, s41, s40
    v_add_u32 v237, s41, v245
    v_add_u32 v238, 103680, v237
    v_mov_b32 v239, v246
    s_mul_i32 s44, s26, 10240
    s_add_u32 s44, s44, s39
    s_add_u32 s45, s44, 5120
    ds_read_b64_tr_b16 v[96:97], v240 offset:0
    ds_read_b64_tr_b16 v[98:99], v240 offset:1280
    ds_read_b64_tr_b16 v[100:101], v240 offset:8
    ds_read_b64_tr_b16 v[102:103], v240 offset:1288
    ds_read_b64_tr_b16 v[104:105], v240 offset:16
    ds_read_b64_tr_b16 v[106:107], v240 offset:1296
    ds_read_b64_tr_b16 v[108:109], v240 offset:24
    ds_read_b64_tr_b16 v[110:111], v240 offset:1304
    ds_read_b64_tr_b16 v[112:113], v240 offset:32
    ds_read_b64_tr_b16 v[114:115], v240 offset:1312
    s_waitcnt vmcnt(0) lgkmcnt(5)
    ds_read_b64_tr_b16 v[116:117], v240 offset:6400
    ds_read_b64_tr_b16 v[118:119], v240 offset:7680
    ds_read_b64_tr_b16 v[120:121], v240 offset:6408
    ds_read_b64_tr_b16 v[122:123], v240 offset:7688
    ds_read_b64_tr_b16 v[124:125], v240 offset:6416
    ds_read_b64_tr_b16 v[126:127], v240 offset:7696
    ds_read_b64_tr_b16 v[128:129], v240 offset:6424
    ds_read_b64_tr_b16 v[130:131], v240 offset:7704
    ds_read_b64_tr_b16 v[132:133], v240 offset:6432
    ds_read_b64_tr_b16 v[134:135], v240 offset:7712
    s_waitcnt lgkmcnt(10)
    v_mfma_f32_16x16x32_bf16 v[8:11], v[96:99], v[32:35], v[8:11]
    ds_read_b64_tr_b16 v[136:137], v240 offset:12800
    ds_read_b64_tr_b16 v[138:139], v240 offset:14080
    v_mfma_f32_16x16x32_bf16 v[12:15], v[100:103], v[32:35], v[12:15]
    ds_read_b64_tr_b16 v[140:141], v240 offset:12808
    ds_read_b64_tr_b16 v[142:143], v240 offset:14088
    v_mfma_f32_16x16x32_bf16 v[16:19], v[104:107], v[32:35], v[16:19]
    v_mfma_f32_16x16x32_bf16 v[20:23], v[108:111], v[32:35], v[20:23]
    v_mfma_f32_16x16x32_bf16 v[24:27], v[112:115], v[32:35], v[24:27]
    s_waitcnt lgkmcnt(9)
    ds_read_b64_tr_b16 v[144:145], v240 offset:12816
    ds_read_b64_tr_b16 v[146:147], v240 offset:14096
    ds_read_b64_tr_b16 v[148:149], v240 offset:12824
    ds_read_b64_tr_b16 v[150:151], v240 offset:14104
    ds_read_b64_tr_b16 v[152:153], v240 offset:12832
    ds_read_b64_tr_b16 v[154:155], v240 offset:14112
    s_waitcnt lgkmcnt(10)
    v_mfma_f32_16x16x32_bf16 v[8:11], v[116:119], v[36:39], v[8:11]
    ds_read_b64_tr_b16 v[96:97], v240 offset:19200
    ds_read_b64_tr_b16 v[98:99], v240 offset:20480
    v_mfma_f32_16x16x32_bf16 v[12:15], v[120:123], v[36:39], v[12:15]
    ds_read_b64_tr_b16 v[100:101], v240 offset:19208
    ds_read_b64_tr_b16 v[102:103], v240 offset:20488
    v_mfma_f32_16x16x32_bf16 v[16:19], v[124:127], v[36:39], v[16:19]
    v_mfma_f32_16x16x32_bf16 v[20:23], v[128:131], v[36:39], v[20:23]
    v_mfma_f32_16x16x32_bf16 v[24:27], v[132:135], v[36:39], v[24:27]
    s_waitcnt lgkmcnt(9)
    ds_read_b64_tr_b16 v[104:105], v240 offset:19216
    ds_read_b64_tr_b16 v[106:107], v240 offset:20496
    ds_read_b64_tr_b16 v[108:109], v240 offset:19224
    ds_read_b64_tr_b16 v[110:111], v240 offset:20504
    ds_read_b64_tr_b16 v[112:113], v240 offset:19232
    ds_read_b64_tr_b16 v[114:115], v240 offset:20512
    s_waitcnt lgkmcnt(10)
    v_mfma_f32_16x16x32_bf16 v[8:11], v[136:139], v[40:43], v[8:11]
    ds_read_b64_tr_b16 v[116:117], v240 offset:25600
    ds_read_b64_tr_b16 v[118:119], v240 offset:26880
    v_mfma_f32_16x16x32_bf16 v[12:15], v[140:143], v[40:43], v[12:15]
    ds_read_b64_tr_b16 v[120:121], v240 offset:25608
    ds_read_b64_tr_b16 v[122:123], v240 offset:26888
    v_mfma_f32_16x16x32_bf16 v[16:19], v[144:147], v[40:43], v[16:19]
    v_mfma_f32_16x16x32_bf16 v[20:23], v[148:151], v[40:43], v[20:23]
    v_mfma_f32_16x16x32_bf16 v[24:27], v[152:155], v[40:43], v[24:27]
    s_waitcnt lgkmcnt(9)
    ds_read_b64_tr_b16 v[124:125], v240 offset:25616
    ds_read_b64_tr_b16 v[126:127], v240 offset:26896
    ds_read_b64_tr_b16 v[128:129], v240 offset:25624
    ds_read_b64_tr_b16 v[130:131], v240 offset:26904
    ds_read_b64_tr_b16 v[132:133], v240 offset:25632
    ds_read_b64_tr_b16 v[134:135], v240 offset:26912
    s_waitcnt lgkmcnt(10)
    v_mfma_f32_16x16x32_bf16 v[8:11], v[96:99], v[44:47], v[8:11]
    ds_read_b64_tr_b16 v[136:137], v240 offset:32000
    ds_read_b64_tr_b16 v[138:139], v240 offset:33280
    v_mfma_f32_16x16x32_bf16 v[12:15], v[100:103], v[44:47], v[12:15]
    ds_read_b64_tr_b16 v[140:141], v240 offset:32008
    ds_read_b64_tr_b16 v[142:143], v240 offset:33288
    v_mfma_f32_16x16x32_bf16 v[16:19], v[104:107], v[44:47], v[16:19]
    v_mfma_f32_16x16x32_bf16 v[20:23], v[108:111], v[44:47], v[20:23]
    v_mfma_f32_16x16x32_bf16 v[24:27], v[112:115], v[44:47], v[24:27]
    s_waitcnt lgkmcnt(9)
    ds_read_b64_tr_b16 v[144:145], v240 offset:32016
    ds_read_b64_tr_b16 v[146:147], v240 offset:33296
    ds_read_b64_tr_b16 v[148:149], v240 offset:32024
    ds_read_b64_tr_b16 v[150:151], v240 offset:33304
    ds_read_b64_tr_b16 v[152:153], v240 offset:32032
    ds_read_b64_tr_b16 v[154:155], v240 offset:33312
    s_waitcnt lgkmcnt(10)
    v_mfma_f32_16x16x32_bf16 v[8:11], v[116:119], v[48:51], v[8:11]
    ds_read_b64_tr_b16 v[96:97], v240 offset:38400
    ds_read_b64_tr_b16 v[98:99], v240 offset:39680
    v_mfma_f32_16x16x32_bf16 v[12:15], v[120:123], v[48:51], v[12:15]
    ds_read_b64_tr_b16 v[100:101], v240 offset:38408
    ds_read_b64_tr_b16 v[102:103], v240 offset:39688
    v_mfma_f32_16x16x32_bf16 v[16:19], v[124:127], v[48:51], v[16:19]
    v_mfma_f32_16x16x32_bf16 v[20:23], v[128:131], v[48:51], v[20:23]
    v_mfma_f32_16x16x32_bf16 v[24:27], v[132:135], v[48:51], v[24:27]
    s_waitcnt lgkmcnt(9)
    ds_read_b64_tr_b16 v[104:105], v240 offset:38416
    ds_read_b64_tr_b16 v[106:107], v240 offset:39696
    ds_read_b64_tr_b16 v[108:109], v240 offset:38424
    ds_read_b64_tr_b16 v[110:111], v240 offset:39704
    ds_read_b64_tr_b16 v[112:113], v240 offset:38432
    ds_read_b64_tr_b16 v[114:115], v240 offset:39712
    s_waitcnt lgkmcnt(10)
    v_mfma_f32_16x16x32_bf16 v[8:11], v[136:139], v[52:55], v[8:11]
    ds_read_b64_tr_b16 v[116:117], v240 offset:44800
    ds_read_b64_tr_b16 v[118:119], v240 offset:46080
    v_mfma_f32_16x16x32_bf16 v[12:15], v[140:143], v[52:55], v[12:15]
    ds_read_b64_tr_b16 v[120:121], v240 offset:44808
    ds_read_b64_tr_b16 v[122:123], v240 offset:46088
    v_mfma_f32_16x16x32_bf16 v[16:19], v[144:147], v[52:55], v[16:19]
    v_mfma_f32_16x16x32_bf16 v[20:23], v[148:151], v[52:55], v[20:23]
    v_mfma_f32_16x16x32_bf16 v[24:27], v[152:155], v[52:55], v[24:27]
    s_waitcnt lgkmcnt(9)
    ds_read_b64_tr_b16 v[124:125], v240 offset:44816
    ds_read_b64_tr_b16 v[126:127], v240 offset:46096
    ds_read_b64_tr_b16 v[128:129], v240 offset:44824
    ds_read_b64_tr_b16 v[130:131], v240 offset:46104
    ds_read_b64_tr_b16 v[132:133], v240 offset:44832
    ds_read_b64_tr_b16 v[134:135], v240 offset:46112
    s_waitcnt lgkmcnt(10)
    v_mfma_f32_16x16x32_bf16 v[8:11], v[96:99], v[56:59], v[8:11]
    ds_read_b64_tr_b16 v[136:137], v241 offset:0
    ds_read_b64_tr_b16 v[138:139], v241 offset:3200
    v_mfma_f32_16x16x32_bf16 v[12:15], v[100:103], v[56:59], v[12:15]
    ds_read_b64_tr_b16 v[140:141], v241 offset:8
    ds_read_b64_tr_b16 v[142:143], v241 offset:3208
    v_mfma_f32_16x16x32_bf16 v[16:19], v[104:107], v[56:59], v[16:19]
    v_mfma_f32_16x16x32_bf16 v[20:23], v[108:111], v[56:59], v[20:23]
    v_mfma_f32_16x16x32_bf16 v[24:27], v[112:115], v[56:59], v[24:27]
    s_waitcnt lgkmcnt(9)
    ds_read_b64_tr_b16 v[144:145], v241 offset:16
    ds_read_b64_tr_b16 v[146:147], v241 offset:3216
    ds_read_b64_tr_b16 v[148:149], v241 offset:24
    ds_read_b64_tr_b16 v[150:151], v241 offset:3224
    ds_read_b64_tr_b16 v[152:153], v241 offset:32
    ds_read_b64_tr_b16 v[154:155], v241 offset:3232
    s_waitcnt lgkmcnt(10)
    v_mfma_f32_16x16x32_bf16 v[8:11], v[116:119], v[60:63], v[8:11]
    ds_read_b64_tr_b16 v[96:97], v241 offset:25600
    ds_read_b64_tr_b16 v[98:99], v241 offset:28800
    v_mfma_f32_16x16x32_bf16 v[12:15], v[120:123], v[60:63], v[12:15]
    ds_read_b64_tr_b16 v[100:101], v241 offset:25608
    ds_read_b64_tr_b16 v[102:103], v241 offset:28808
    v_mfma_f32_16x16x32_bf16 v[16:19], v[124:127], v[60:63], v[16:19]
    v_mfma_f32_16x16x32_bf16 v[20:23], v[128:131], v[60:63], v[20:23]
    v_mfma_f32_16x16x32_bf16 v[24:27], v[132:135], v[60:63], v[24:27]
    s_waitcnt lgkmcnt(9)
    ds_read_b64_tr_b16 v[104:105], v241 offset:25616
    ds_read_b64_tr_b16 v[106:107], v241 offset:28816
    ds_read_b64_tr_b16 v[108:109], v241 offset:25624
    ds_read_b64_tr_b16 v[110:111], v241 offset:28824
    ds_read_b64_tr_b16 v[112:113], v241 offset:25632
    ds_read_b64_tr_b16 v[114:115], v241 offset:28832
    s_waitcnt lgkmcnt(10)
    v_mfma_f32_16x16x32_bf16 v[8:11], v[136:139], v[64:67], v[8:11]
    v_mfma_f32_16x16x32_bf16 v[12:15], v[140:143], v[64:67], v[12:15]
    v_mfma_f32_16x16x32_bf16 v[16:19], v[144:147], v[64:67], v[16:19]
    v_mfma_f32_16x16x32_bf16 v[20:23], v[148:151], v[64:67], v[20:23]
    v_mfma_f32_16x16x32_bf16 v[24:27], v[152:155], v[64:67], v[24:27]
    s_waitcnt lgkmcnt(0)
    v_mfma_f32_16x16x32_bf16 v[8:11], v[96:99], v[68:71], v[8:11]
    v_mfma_f32_16x16x32_bf16 v[12:15], v[100:103], v[68:71], v[12:15]
    v_mfma_f32_16x16x32_bf16 v[16:19], v[104:107], v[68:71], v[16:19]
    v_mfma_f32_16x16x32_bf16 v[20:23], v[108:111], v[68:71], v[20:23]
    v_mfma_f32_16x16x32_bf16 v[24:27], v[112:115], v[68:71], v[24:27]
    s_add_u32 s40, s30, 8192
    buffer_load_dwordx4 v[72:75], v4, s[12:15], s40 offen offset:0 sc1
    s_add_u32 s40, s30, 8192
    buffer_load_dwordx4 v[76:79], v4, s[12:15], s40 offen offset:1024 sc1
    s_add_u32 s40, s30, 8192
    buffer_load_dwordx4 v[80:83], v4, s[12:15], s40 offen offset:2048 sc1
    s_add_u32 s40, s30, 8192
    buffer_load_dwordx4 v[84:87], v4, s[12:15], s40 offen offset:3072 sc1
    buffer_load_dwordx2 v[88:89], v242, s[12:15], s52 offen offset:2048 sc1
    buffer_load_dwordx2 v[90:91], v242, s[12:15], s52 offen offset:2176 sc1
    v_mov_b32 v254, 156928
    v_mov_b32 v255, 1
    s_add_u32 s64, s64, 4
    s_waitcnt lgkmcnt(0)
    s_mov_b64 exec, 1
    ds_add_rtn_u32 v255, v254, v255
    s_mov_b64 exec, -1
    s_waitcnt lgkmcnt(0)
    v_readfirstlane_b32 s40, v255
    s_add_u32 s40, s40, 1
    s_cmp_ge_u32 s40, s64
    s_cbranch_scc1 L_gs_95
    s_mov_b32 s68, 0x2000000
L_lw_96:
    ds_read_b32 v255, v254
    s_sub_u32 s68, s68, 1
    s_cbranch_scc1 L_lwd_97
    s_waitcnt lgkmcnt(0)
    v_readfirstlane_b32 s40, v255
    s_cmp_ge_u32 s40, s64
    s_cbranch_scc1 L_lwd_97
    s_sleep 0
    s_branch L_lw_96
L_lwd_97:
    s_waitcnt lgkmcnt(0)
L_gs_95:
    s_branch L_p3c
L_p3b:
    v_mov_b32 v8, 0
    v_mov_b32 v9, 0
    v_mov_b32 v10, 0
    v_mov_b32 v11, 0
    v_mov_b32 v12, 0
    v_mov_b32 v13, 0
    v_mov_b32 v14, 0
    v_mov_b32 v15, 0
    v_mov_b32 v16, 0
    v_mov_b32 v17, 0
    v_mov_b32 v18, 0
    v_mov_b32 v19, 0
    v_mov_b32 v20, 0
    v_mov_b32 v21, 0
    v_mov_b32 v22, 0
    v_mov_b32 v23, 0
    v_mov_b32 v24, 0
    v_mov_b32 v25, 0
    v_mov_b32 v26, 0
    v_mov_b32 v27, 0
    v_add_u32 v240, 25600, v240
    v_add_u32 v241, 25600, v241
    s_add_u32 s30, s30, 4096
    s_add_u32 s52, s52, 1024
    s_add_u32 s40, s30, 8192
    buffer_load_dwordx4 v[72:75], v4, s[12:15], s40 offen offset:0 sc1
    s_add_u32 s40, s30, 8192
    buffer_load_dwordx4 v[76:79], v4, s[12:15], s40 offen offset:1024 sc1
    s_add_u32 s40, s30, 8192
    buffer_load_dwordx4 v[80:83], v4, s[12:15], s40 offen offset:2048 sc1
    s_add_u32 s40, s30, 8192
    buffer_load_dwordx4 v[84:87], v4, s[12:15], s40 offen offset:3072 sc1
    buffer_load_dwordx2 v[88:89], v242, s[12:15], s52 offen offset:2048 sc1
    buffer_load_dwordx2 v[90:91], v242, s[12:15], s52 offen offset:2176 sc1
    s_mul_i32 s40, s25, 5376
    s_mul_i32 s41, s26, 103680
    s_add_u32 s41, s41, s40
    v_add_u32 v236, s41, v244
    s_mul_i32 s41, s26, 2688
    s_add_u32 s41, s41, s40
    v_add_u32 v237, s41, v245
    v_add_u32 v238, 103680, v237
    v_mov_b32 v239, v246
    s_mul_i32 s44, s26, 10240
    s_add_u32 s44, s44, s39
    s_add_u32 s45, s44, 5120
L_p3c:
    v_add_u32 v240, 51200, v240
    v_add_u32 v241, 51200, v241
    s_add_u32 s54, s54, 32768
    ds_read_b64_tr_b16 v[96:97], v240 offset:0
    ds_read_b64_tr_b16 v[98:99], v240 offset:1280
    ds_read_b64_tr_b16 v[100:101], v240 offset:8
    ds_read_b64_tr_b16 v[102:103], v240 offset:1288
    ds_read_b64_tr_b16 v[104:105], v240 offset:16
    ds_read_b64_tr_b16 v[106:107], v240 offset:1296
    ds_read_b64_tr_b16 v[108:109], v240 offset:24
    ds_read_b64_tr_b16 v[110:111], v240 offset:1304
    ds_read_b64_tr_b16 v[112:113], v240 offset:32
    ds_read_b64_tr_b16 v[114:115], v240 offset:1312
    s_waitcnt lgkmcnt(5)
    ds_read_b64_tr_b16 v[116:117], v240 offset:6400
    ds_read_b64_tr_b16 v[118:119], v240 offset:7680
    ds_read_b64_tr_b16 v[120:121], v240 offset:6408
    ds_read_b64_tr_b16 v[122:123], v240 offset:7688
    ds_read_b64_tr_b16 v[124:125], v240 offset:6416
    ds_read_b64_tr_b16 v[126:127], v240 offset:7696
    ds_read_b64_tr_b16 v[128:129], v240 offset:6424
    ds_read_b64_tr_b16 v[130:131], v240 offset:7704
    ds_read_b64_tr_b16 v[132:133], v240 offset:6432
    ds_read_b64_tr_b16 v[134:135], v240 offset:7712
    s_waitcnt lgkmcnt(5)
    ds_read_b64_tr_b16 v[136:137], v240 offset:12800
    ds_read_b64_tr_b16 v[138:139], v240 offset:14080
    ds_read_b64_tr_b16 v[140:141], v240 offset:12808
    ds_read_b64_tr_b16 v[142:143], v240 offset:14088
    ds_read_b64_tr_b16 v[144:145], v240 offset:12816
    ds_read_b64_tr_b16 v[146:147], v240 offset:14096
    ds_read_b64_tr_b16 v[148:149], v240 offset:12824
    ds_read_b64_tr_b16 v[150:151], v240 offset:14104
    ds_read_b64_tr_b16 v[152:153], v240 offset:12832
    ds_read_b64_tr_b16 v[154:155], v240 offset:14112
    s_waitcnt lgkmcnt(5)
    ds_read_b64_tr_b16 v[156:157], v240 offset:19200
    ds_read_b64_tr_b16 v[158:159], v240 offset:20480
    ds_read_b64_tr_b16 v[160:161], v240 offset:19208
    ds_read_b64_tr_b16 v[162:163], v240 offset:20488
    ds_read_b64_tr_b16 v[164:165], v240 offset:19216
    ds_read_b64_tr_b16 v[166:167], v240 offset:20496
    ds_read_b64_tr_b16 v[168:169], v240 offset:19224
    ds_read_b64_tr_b16 v[170:171], v240 offset:20504
    ds_read_b64_tr_b16 v[172:173], v240 offset:19232
    ds_read_b64_tr_b16 v[174:175], v240 offset:20512
    s_waitcnt lgkmcnt(5)
    ds_read_b64_tr_b16 v[176:177], v241 offset:0
    ds_read_b64_tr_b16 v[178:179], v241 offset:3200
    ds_read_b64_tr_b16 v[180:181], v241 offset:8
    ds_read_b64_tr_b16 v[182:183], v241 offset:3208
    ds_read_b64_tr_b16 v[184:185], v241 offset:16
    ds_read_b64_tr_b16 v[186:187], v241 offset:3216
    ds_read_b64_tr_b16 v[188:189], v241 offset:24
    ds_read_b64_tr_b16 v[190:191], v241 offset:3224
    ds_read_b64_tr_b16 v[192:193], v241 offset:32
    ds_read_b64_tr_b16 v[194:195], v241 offset:3232
    s_waitcnt lgkmcnt(0)
    v_lshlrev_b32 v232, 4, v1
    s_mul_i32 s40, s25, 3072
    s_add_u32 s40, s40, 103680
    v_add_u32 v233, s40, v232
    s_lshl_b32 s40, s25, 11
    s_add_u32 s40, s40, 140544
    v_add_u32 v232, s40, v232
    s_mov_b32 s68, 0x100000
    s_waitcnt vmcnt(5)
L_oc_98:
    v_max3_u32 v234, v72, v73, v74
    v_max_u32 v234, v234, v75
    v_cmp_eq_u32 vcc, -1, v234
    s_cbranch_vccz L_ook_99
    s_cmp_eq_u32 s68, 0
    s_cbranch_scc1 L_ook_99
    s_sub_u32 s68, s68, 1
    s_sleep 1
    s_add_u32 s40, s30, 8192
    buffer_load_dwordx4 v[72:75], v4, s[12:15], s40 offen offset:0 sc1
    s_add_u32 s40, s30, 8192
    buffer_load_dwordx4 v[76:79], v4, s[12:15], s40 offen offset:1024 sc1
    s_add_u32 s40, s30, 8192
    buffer_load_dwordx4 v[80:83], v4, s[12:15], s40 offen offset:2048 sc1
    s_add_u32 s40, s30, 8192
    buffer_load_dwordx4 v[84:87], v4, s[12:15], s40 offen offset:3072 sc1
    buffer_load_dwordx2 v[88:89], v242, s[12:15], s52 offen offset:2048 sc1
    buffer_load_dwordx2 v[90:91], v242, s[12:15], s52 offen offset:2176 sc1
    s_waitcnt vmcnt(5)
    s_branch L_oc_98
L_ook_99:
    v_mfma_f32_16x16x32_bf16 v[8:11], v[96:99], v[72:75], v[8:11]
    v_mfma_f32_16x16x32_bf16 v[12:15], v[100:103], v[72:75], v[12:15]
    v_mfma_f32_16x16x32_bf16 v[16:19], v[104:107], v[72:75], v[16:19]
    v_mfma_f32_16x16x32_bf16 v[20:23], v[108:111], v[72:75], v[20:23]
    v_mfma_f32_16x16x32_bf16 v[24:27], v[112:115], v[72:75], v[24:27]
    s_waitcnt vmcnt(4)
L_oc_100:
    v_max3_u32 v234, v76, v77, v78
    v_max_u32 v234, v234, v79
    v_cmp_eq_u32 vcc, -1, v234
    s_cbranch_vccz L_ook_101
    s_cmp_eq_u32 s68, 0
    s_cbranch_scc1 L_ook_101
    s_sub_u32 s68, s68, 1
    s_sleep 1
    s_add_u32 s40, s30, 8192
    buffer_load_dwordx4 v[76:79], v4, s[12:15], s40 offen offset:1024 sc1
    s_add_u32 s40, s30, 8192
    buffer_load_dwordx4 v[80:83], v4, s[12:15], s40 offen offset:2048 sc1
    s_add_u32 s40, s30, 8192
    buffer_load_dwordx4 v[84:87], v4, s[12:15], s40 offen offset:3072 sc1
    buffer_load_dwordx2 v[88:89], v242, s[12:15], s52 offen offset:2048 sc1
    buffer_load_dwordx2 v[90:91], v242, s[12:15], s52 offen offset:2176 sc1
    s_waitcnt vmcnt(4)
    s_branch L_oc_100
L_ook_101:
    v_mfma_f32_16x16x32_bf16 v[8:11], v[116:119], v[76:79], v[8:11]
    v_mfma_f32_16x16x32_bf16 v[12:15], v[120:123], v[76:79], v[12:15]
    v_mfma_f32_16x16x32_bf16 v[16:19], v[124:127], v[76:79], v[16:19]
    v_mfma_f32_16x16x32_bf16 v[20:23], v[128:131], v[76:79], v[20:23]
    v_mfma_f32_16x16x32_bf16 v[24:27], v[132:135], v[76:79], v[24:27]
    s_waitcnt vmcnt(3)
L_oc_102:
    v_max3_u32 v234, v80, v81, v82
    v_max_u32 v234, v234, v83
    v_cmp_eq_u32 vcc, -1, v234
    s_cbranch_vccz L_ook_103
    s_cmp_eq_u32 s68, 0
    s_cbranch_scc1 L_ook_103
    s_sub_u32 s68, s68, 1
    s_sleep 1
    s_add_u32 s40, s30, 8192
    buffer_load_dwordx4 v[80:83], v4, s[12:15], s40 offen offset:2048 sc1
    s_add_u32 s40, s30, 8192
    buffer_load_dwordx4 v[84:87], v4, s[12:15], s40 offen offset:3072 sc1
    buffer_load_dwordx2 v[88:89], v242, s[12:15], s52 offen offset:2048 sc1
    buffer_load_dwordx2 v[90:91], v242, s[12:15], s52 offen offset:2176 sc1
    s_waitcnt vmcnt(3)
    s_branch L_oc_102
L_ook_103:
    v_mfma_f32_16x16x32_bf16 v[8:11], v[136:139], v[80:83], v[8:11]
    v_mfma_f32_16x16x32_bf16 v[12:15], v[140:143], v[80:83], v[12:15]
    v_mfma_f32_16x16x32_bf16 v[16:19], v[144:147], v[80:83], v[16:19]
    v_mfma_f32_16x16x32_bf16 v[20:23], v[148:151], v[80:83], v[20:23]
    v_mfma_f32_16x16x32_bf16 v[24:27], v[152:155], v[80:83], v[24:27]
    s_waitcnt vmcnt(2)
L_oc_104:
    v_max3_u32 v234, v84, v85, v86
    v_max_u32 v234, v234, v87
    v_cmp_eq_u32 vcc, -1, v234
    s_cbranch_vccz L_ook_105
    s_cmp_eq_u32 s68, 0
    s_cbranch_scc1 L_ook_105
    s_sub_u32 s68, s68, 1
    s_sleep 1
    s_add_u32 s40, s30, 8192
    buffer_load_dwordx4 v[84:87], v4, s[12:15], s40 offen offset:3072 sc1
    buffer_load_dwordx2 v[88:89], v242, s[12:15], s52 offen offset:2048 sc1
    buffer_load_dwordx2 v[90:91], v242, s[12:15], s52 offen offset:2176 sc1
    s_waitcnt vmcnt(2)
    s_branch L_oc_104
L_ook_105:
    v_mfma_f32_16x16x32_bf16 v[8:11], v[156:159], v[84:87], v[8:11]
    v_mfma_f32_16x16x32_bf16 v[12:15], v[160:163], v[84:87], v[12:15]
    v_mfma_f32_16x16x32_bf16 v[16:19], v[164:167], v[84:87], v[16:19]
    v_mfma_f32_16x16x32_bf16 v[20:23], v[168:171], v[84:87], v[20:23]
    v_mfma_f32_16x16x32_bf16 v[24:27], v[172:175], v[84:87], v[24:27]
    s_waitcnt vmcnt(0)
L_oc_106:
    v_max3_u32 v234, v88, v89, v90
    v_max_u32 v234, v234, v91
    v_cmp_eq_u32 vcc, -1, v234
    s_cbranch_vccz L_ook_107
    s_cmp_eq_u32 s68, 0
    s_cbranch_scc1 L_ook_107
    s_sub_u32 s68, s68, 1
    s_sleep 1
    buffer_load_dwordx2 v[88:89], v242, s[12:15], s52 offen offset:2048 sc1
    buffer_load_dwordx2 v[90:91], v242, s[12:15], s52 offen offset:2176 sc1
    s_waitcnt vmcnt(0)
    s_branch L_oc_106
L_ook_107:
    v_mfma_f32_16x16x32_bf16 v[8:11], v[176:179], v[88:91], v[8:11]
    v_mfma_f32_16x16x32_bf16 v[12:15], v[180:183], v[88:91], v[12:15]
    v_mfma_f32_16x16x32_bf16 v[16:19], v[184:187], v[88:91], v[16:19]
    v_mfma_f32_16x16x32_bf16 v[20:23], v[188:191], v[88:91], v[20:23]
    v_mfma_f32_16x16x32_bf16 v[24:27], v[192:195], v[88:91], v[24:27]
    s_nop 3
    ds_write_b128 v236, v[8:11] offset:0
    ds_write_b128 v236, v[12:15] offset:16
    ds_write_b128 v236, v[16:19] offset:32
    ds_write_b128 v236, v[20:23] offset:48
    ds_write_b128 v236, v[24:27] offset:64
    s_waitcnt lgkmcnt(0)
    s_barrier
    ds_read_b128 v[32:35], v237 offset:0
    ds_read_b128 v[40:43], v238 offset:0
    ds_read_b128 v[36:39], v237 offset:16
    ds_read_b128 v[44:47], v238 offset:16
    ds_read_b128 v[48:51], v237 offset:1344
    ds_read_b128 v[56:59], v238 offset:1344
    ds_read_b128 v[52:55], v237 offset:1360
    ds_read_b128 v[60:63], v238 offset:1360
    s_mov_b32 exec_hi, 0xff
    s_waitcnt lgkmcnt(4)
    v_pk_add_f32 v[32:33], v[32:33], v[40:41]
    v_pk_add_f32 v[34:35], v[34:35], v[42:43]
    v_pk_add_f32 v[36:37], v[36:37], v[44:45]
    v_pk_add_f32 v[38:39], v[38:39], v[46:47]
    v_cvt_pk_bf16_f32 v40, v32, v33
    v_cvt_pk_bf16_f32 v41, v34, v35
    v_cvt_pk_bf16_f32 v42, v36, v37
    v_cvt_pk_bf16_f32 v43, v38, v39
    buffer_store_dwordx4 v[40:43], v239, s[16:19], s44 offen nt
    s_waitcnt lgkmcnt(0)
    v_pk_add_f32 v[48:49], v[48:49], v[56:57]
    v_pk_add_f32 v[50:51], v[50:51], v[58:59]
    v_pk_add_f32 v[52:53], v[52:53], v[60:61]
    v_pk_add_f32 v[54:55], v[54:55], v[62:63]
    v_cvt_pk_bf16_f32 v56, v48, v49
    v_cvt_pk_bf16_f32 v57, v50, v51
    v_cvt_pk_bf16_f32 v58, v52, v53
    v_cvt_pk_bf16_f32 v59, v54, v55
    buffer_store_dwordx4 v[56:59], v239, s[16:19], s45 offen nt
    s_mov_b64 exec, -1
L_fin:
L_end:
    s_endpgm
.section .rodata,"a"
.p2align 6
.amdhsa_kernel parallel_sum__softmax_full_mha__moe_arch_mod__prompt_kernel
  .amdhsa_next_free_vgpr 256
  .amdhsa_next_free_sgpr 102
  .amdhsa_accum_offset 256
  .amdhsa_group_segment_fixed_size 0
  .amdhsa_kernarg_size 88
  .amdhsa_user_sgpr_count 2
  .amdhsa_user_sgpr_kernarg_segment_ptr 1
  .amdhsa_system_sgpr_workgroup_id_x 1
  .amdhsa_float_denorm_mode_32 3
.end_amdhsa_kernel
```
